```python
import torch

def _softmax(x, axis=-1):
    return torch.softmax(x, dim=axis)
def _gelu(x):
    return torch.nn.functional.gelu(x, approximate="tanh")
def _silu(x):
    return torch.nn.functional.silu(x)
def _sigmoid(x):
    return torch.sigmoid(x)
def _layernorm(x, axis=-1, eps=1e-5):
    m = x.mean(dim=axis, keepdim=True)
    v = x.var(dim=axis, keepdim=True, unbiased=False)
    return (x - m) / torch.sqrt(v + eps)
def _scatter_add(tgt, idx, src, axis=0):
    return tgt.clone().index_add_(axis, idx, src)
def _segment_sum(src, seg, n):
    out = torch.zeros((n,) + src.shape[1:], dtype=src.dtype)
    return out.index_add_(0, seg, src)
def _pad(x, pw):
    flat = tuple(v for pair in reversed(pw) for v in pair)
    return torch.nn.functional.pad(x, flat)

kernel_name = 'standalone__weight_only_int_quip__prompt'

def setup_inputs():

    _w = (lambda a: (lambda t: t.to(torch.bfloat16) if t.is_floating_point() else t)(torch.as_tensor(a)))
    B, S, D, F = 1, 2048, 640, 1728
    G = 64 if 64 > 0 else D
    D = (D // G) * G
    ng = D // G
    bits = 8 if 8 > 0 else 4
    qmax = 1 << bits
    qw = torch.randint(0, qmax, (D, F)).to(torch.int32)
    U, _ = (lambda *_a, **_k: torch.linalg.qr(*[torch.as_tensor(_x).float() for _x in _a], **_k))((lambda *s: torch.randn(*s, dtype=torch.bfloat16) * 0.05)(D, D))
    V, _ = (lambda *_a, **_k: torch.linalg.qr(*[torch.as_tensor(_x).float() for _x in _a], **_k))((lambda *s: torch.randn(*s, dtype=torch.bfloat16) * 0.05)(F, F))
    return {
        "x": _w((lambda *s: torch.randn(*s, dtype=torch.bfloat16) * 0.05)(B, S, D)),
        "qw": _w(qw),
        "scales": _w(torch.abs((lambda *s: torch.randn(*s, dtype=torch.bfloat16) * 0.05)(ng, F)) * 0.02 + 0.005),
        "zeros": _w(torch.full((ng, F), qmax / 2.0, dtype=float)),
        "U": _w(U.to(float)),
        "V": _w(V.to(float)),
    }

def reference(x, qw, scales, zeros, U, V):
    B, S, D = x.shape
    ng, F = scales.shape
    G = D // ng
    s = (lambda x, n, axis: torch.repeat_interleave(x, n, dim=axis))(scales, G, axis=0)
    z = (lambda x, n, axis: torch.repeat_interleave(x, n, dim=axis))(zeros, G, axis=0)
    wq = ((lambda x, dt: x.to(dt))(qw, x.dtype) - z) * s
    xr = torch.einsum("bsd,de->bse", x, U)
    h  = torch.einsum("bse,ef->bsf", xr, wq)
    y  = torch.einsum("bsf,fg->bsg", h, V)
    return y
```

```asm
; @launch grid=(256,1,1) block=(256,1,1) lds=163840
.amdgcn_target "amdgcn-amd-amdhsa--gfx950"
.text
.globl standalone__weight_only_int_quip__prompt_kernel
.p2align 8
.type standalone__weight_only_int_quip__prompt_kernel,@function
standalone__weight_only_int_quip__prompt_kernel:
    s_cmp_ge_u32 s2, 256
    s_cbranch_scc1 standalone__weight_only_int_quip__prompt_kernel_done
    s_load_dwordx16 s[44:59], s[0:1], 0
    s_load_dwordx2 s[60:61], s[0:1], 64

    v_lshrrev_b32 v1, 6, v0
    v_and_b32 v2, 63, v0
    v_readfirstlane_b32 s3, v1
    s_and_b32 s4, s2, 7
    s_lshr_b32 s5, s2, 3

    s_cmp_lg_u32 s3, 3
    s_cbranch_scc1 L_nocpf
    s_getpc_b64 s[8:9]
L_pc:
    s_sub_u32 s8, s8, L_pc-standalone__weight_only_int_quip__prompt_kernel
    s_subb_u32 s9, s9, 0
    s_mov_b32 s10, L_codeend-standalone__weight_only_int_quip__prompt_kernel
    s_mov_b32 s11, 0x20000
    s_lshl_b32 s92, s5, 10
    v_lshlrev_b32 v3, 4, v2
    buffer_load_dwordx4 v[248:251], v3, s[8:11], s92 offen
    s_add_u32 s92, s92, 32768
    buffer_load_dwordx4 v[252:255], v3, s[8:11], s92 offen
L_nocpf:

    s_mul_i32 s63, s5, 37
    s_lshr_b32 s63, s63, 8
    s_mul_i32 s62, s63, 7
    s_sub_u32 s62, s5, s62
    s_and_b32 s92, s4, 1
    s_mul_i32 s92, s92, 7
    s_add_u32 s62, s62, s92
    s_lshr_b32 s92, s4, 1
    s_lshl_b32 s92, s92, 2
    s_add_u32 s63, s63, s92

    s_cmp_eq_u32 s4, 6
    s_cselect_b32 s92, 21, 28
    s_cselect_b32 s95, 29, 32
    s_cmp_eq_u32 s4, 7
    s_cselect_b32 s92, 0, s92
    s_cselect_b32 s93, 8, s4
    s_mul_i32 s36, s4, 28
    s_add_u32 s36, s36, s5
    s_lshl_b32 s93, s93, 2
    s_add_u32 s93, s93, s5
    s_sub_u32 s93, s93, s92
    s_cmp_ge_u32 s5, s95
    s_cselect_b32 s93, 64, s93
    s_cmp_ge_u32 s5, s92
    s_cselect_b32 s36, s93, s36
    s_cselect_b32 s94, 1, 0

    s_cmp_eq_u32 s94, 1
    s_cbranch_scc1 L_xrole
    s_mul_i32 s6, s36, 9363
    s_lshr_b32 s6, s6, 16
    s_mul_i32 s7, s6, 7
    s_sub_u32 s7, s36, s7

    s_cmp_eq_u32 s3, 3
    s_cbranch_scc1 standalone__weight_only_int_quip__prompt_kernel_loader1
    s_mov_b32 s10, 4423680
    s_mov_b32 s11, 0x20000
    s_mov_b32 s14, 34560
    s_mov_b32 s15, 0x20000
    s_mov_b32 s18, 34560
    s_mov_b32 s19, 0x20000
    s_lshl_b32 s25, s6, 6
    v_and_b32 v4, 3, v2
    v_lshl_add_u32 v7, v4, 3, s25
    v_lshrrev_b32 v3, 2, v2
    v_mul_u32_u24 v8, 1728, v3
    v_add_lshl_u32 v8, v8, v7, 2
    v_lshlrev_b32 v9, 1, v7
    s_mul_i32 s26, s7, 3
    s_add_u32 s26, s26, s3
    s_mul_i32 s28, s26, 221184
    s_add_u32 s29, s28, 110592
    s_lshr_b32 s27, s26, 1
    s_mul_i32 s27, s27, 3456
    s_waitcnt lgkmcnt(0)
    s_mov_b64 s[8:9], s[46:47]
    s_mov_b64 s[12:13], s[48:49]
    s_mov_b64 s[16:17], s[50:51]

    buffer_load_dwordx4 v[64:67], v8, s[8:11], s28 offen offset:0
    buffer_load_dwordx4 v[68:71], v8, s[8:11], s28 offen offset:16
    buffer_load_dwordx4 v[96:99], v9, s[12:15], s27 offen offset:0
    buffer_load_dwordx4 v[100:103], v9, s[16:19], s27 offen offset:0
    buffer_load_dwordx4 v[72:75], v8, s[8:11], s29 offen offset:0
    buffer_load_dwordx4 v[76:79], v8, s[8:11], s29 offen offset:16
    buffer_load_dwordx4 v[80:83], v8, s[8:11], s28 offen offset:128
    buffer_load_dwordx4 v[84:87], v8, s[8:11], s28 offen offset:144
    buffer_load_dwordx4 v[104:107], v9, s[12:15], s27 offen offset:64
    buffer_load_dwordx4 v[108:111], v9, s[16:19], s27 offen offset:64
    buffer_load_dwordx4 v[88:91], v8, s[8:11], s29 offen offset:128
    buffer_load_dwordx4 v[92:95], v8, s[8:11], s29 offen offset:144
    s_add_u32 s32, s60, 7159808
    s_addc_u32 s33, s61, 0
    s_mov_b32 s34, 150784
    s_mov_b32 s35, 0x20000
    s_load_dword s39, s[32:33], 99328
    s_mov_b32 s20, s54
    s_mov_b32 s21, s55
    s_mov_b32 s22, 5971968
    s_mov_b32 s23, 0x20000
    v_lshrrev_b32 v3, 3, v2
    v_and_b32 v4, 7, v2
    v_bfe_u32 v5, v2, 4, 1
    v_lshlrev_b32 v5, 2, v5
    v_xor_b32 v4, v4, v5
    v_mul_u32_u24 v3, 3456, v3
    v_lshl_add_u32 v16, v4, 4, v3
    v_add_u32 v17, 26624, v16
    v_add_u32 v18, 53248, v16
    v_add_u32 v19, 79872, v16
    s_lshl_b32 s24, s6, 7
    s_mul_i32 s26, s3, 40960
    s_mul_i32 s99, s7, 1

    s_mul_i32 s25, s3, 110592
    s_add_u32 s24, s24, s25
    s_mul_i32 s40, s7, 54
    s_lshl_b32 s25, s6, 1
    s_add_u32 s40, s40, s25
    s_mul_i32 s40, s40, 6144
    s_lshl_b32 s25, s3, 10
    s_cmp_eq_u32 s3, 2
    s_cselect_b32 s25, 4096, s25
    s_cselect_b32 s93, 10, 11
    s_add_u32 s40, s40, s25
    s_add_u32 s41, s40, 6144
    v_and_b32 v26, 15, v2
    v_lshrrev_b32 v3, 4, v2
    v_lshl_add_u32 v22, v26, 2, v3
    v_lshlrev_b32 v22, 2, v22
    v_lshlrev_b32 v26, 4, v26
    v_and_b32 v3, 1, v3
    v_lshl_add_u32 v26, v3, 9, v26
    v_lshrrev_b32 v3, 5, v2
    v_lshlrev_b32 v5, s93, v3
    v_add_u32 v26, v26, v5

    s_add_u32 s28, s99, 6
    s_cmp_ge_u32 s28, 14
    s_cselect_b32 s92, 14, 0
    s_sub_u32 s28, s28, s92
    s_mul_i32 s92, s28, 442368
    s_add_u32 s24, s24, s92

    s_mul_i32 s27, s7, 54
    s_add_u32 s27, s27, s3
    s_mul_i32 s27, s27, 6144
    s_cmp_ge_u32 s3, 2
    s_cselect_b32 s30, 13, 99
    v_lshlrev_b32 v20, 4, v2
    s_lshr_b32 s92, s3, 1
    s_lshl_b32 s92, s92, 8
    v_xor_b32 v21, s92, v20
    v_add_u32 v27, 4096, v21
    v_add_u32 v23, s26, v20
    v_lshrrev_b32 v3, 5, v2
    v_bfe_u32 v4, v2, 2, 2
    v_lshl_add_u32 v4, v3, 3, v4
    v_lshlrev_b32 v4, 7, v4
    v_bfe_u32 v5, v2, 4, 1
    v_lshl_add_u32 v4, v5, 5, v4
    v_and_b32 v5, 3, v2
    v_lshl_add_u32 v4, v5, 3, v4
    v_add_u32 v4, s26, v4
    v_bfe_u32 v5, v2, 3, 1
    v_lshl_add_u32 v24, v5, 6, v4
    s_and_b32 s92, s3, 1
    s_lshl_b32 s92, s92, 6
    v_xor_b32 v24, s92, v24
    v_xor_b32 v25, 64, v24
    s_mul_i32 s92, s7, 27
    v_add_u32 v28, s92, v2
    v_lshlrev_b32 v28, 8, v28
    s_lshl_b32 s93, s6, 3
    s_add_u32 s93, s93, 102400
    v_add_u32 v28, s93, v28
    s_add_u32 s92, s92, s6
    s_lshl_b32 s92, s92, 8
    s_add_u32 s92, s92, 102400
    v_min_u32 v29, 26, v2
    v_lshl_add_u32 v29, v29, 3, s92

    s_mov_b32 s12, s60
    s_mov_b32 s13, s61
    s_mov_b32 s14, 2322432
    s_mov_b32 s15, 0x20000
    s_add_u32 s16, s60, 2326528
    s_addc_u32 s17, s61, 0
    s_mov_b32 s18, 2211840
    s_mov_b32 s19, 0x20000
    s_waitcnt lgkmcnt(0)
    s_mul_i32 s38, s39, 0x9E3779B1
    s_add_u32 s38, s38, 0x7F4A7C15
    s_xor_b32 s39, s38, 0x5BD1E995

    s_waitcnt vmcnt(8)
    v_cvt_f32_i32 v64, v64
    v_cvt_f32_i32 v65, v65
    v_cvt_f32_i32 v66, v66
    v_cvt_f32_i32 v67, v67
    v_cvt_f32_i32 v68, v68
    v_cvt_f32_i32 v69, v69
    v_cvt_f32_i32 v70, v70
    v_cvt_f32_i32 v71, v71
    v_cvt_pk_bf16_f32 v128, v64, v65
    v_cvt_pk_bf16_f32 v129, v66, v67
    v_cvt_pk_bf16_f32 v130, v68, v69
    v_cvt_pk_bf16_f32 v131, v70, v71
    v_lshlrev_b32 v120, 16, v100
    v_and_b32 v121, 0xffff0000, v100
    v_lshlrev_b32 v122, 16, v101
    v_and_b32 v123, 0xffff0000, v101
    v_lshlrev_b32 v124, 16, v102
    v_and_b32 v125, 0xffff0000, v102
    v_lshlrev_b32 v126, 16, v103
    v_and_b32 v127, 0xffff0000, v103
    v_lshlrev_b32 v64, 16, v128
    v_and_b32 v65, 0xffff0000, v128
    v_lshlrev_b32 v66, 16, v129
    v_and_b32 v67, 0xffff0000, v129
    v_lshlrev_b32 v68, 16, v130
    v_and_b32 v69, 0xffff0000, v130
    v_lshlrev_b32 v70, 16, v131
    v_and_b32 v71, 0xffff0000, v131
    v_pk_add_f32 v[64:65], v[64:65], v[120:121] neg_lo:[0,1] neg_hi:[0,1]
    v_pk_add_f32 v[66:67], v[66:67], v[122:123] neg_lo:[0,1] neg_hi:[0,1]
    v_pk_add_f32 v[68:69], v[68:69], v[124:125] neg_lo:[0,1] neg_hi:[0,1]
    v_pk_add_f32 v[70:71], v[70:71], v[126:127] neg_lo:[0,1] neg_hi:[0,1]
    v_cvt_pk_bf16_f32 v128, v64, v65
    v_cvt_pk_bf16_f32 v129, v66, v67
    v_cvt_pk_bf16_f32 v130, v68, v69
    v_cvt_pk_bf16_f32 v131, v70, v71
    v_lshlrev_b32 v112, 16, v96
    v_and_b32 v113, 0xffff0000, v96
    v_lshlrev_b32 v114, 16, v97
    v_and_b32 v115, 0xffff0000, v97
    v_lshlrev_b32 v116, 16, v98
    v_and_b32 v117, 0xffff0000, v98
    v_lshlrev_b32 v118, 16, v99
    v_and_b32 v119, 0xffff0000, v99
    v_lshlrev_b32 v64, 16, v128
    v_and_b32 v65, 0xffff0000, v128
    v_lshlrev_b32 v66, 16, v129
    v_and_b32 v67, 0xffff0000, v129
    v_lshlrev_b32 v68, 16, v130
    v_and_b32 v69, 0xffff0000, v130
    v_lshlrev_b32 v70, 16, v131
    v_and_b32 v71, 0xffff0000, v131
    v_pk_mul_f32 v[64:65], v[64:65], v[112:113]
    v_pk_mul_f32 v[66:67], v[66:67], v[114:115]
    v_pk_mul_f32 v[68:69], v[68:69], v[116:117]
    v_pk_mul_f32 v[70:71], v[70:71], v[118:119]
    v_cvt_pk_bf16_f32 v136, v64, v65
    v_cvt_pk_bf16_f32 v137, v66, v67
    v_cvt_pk_bf16_f32 v138, v68, v69
    v_cvt_pk_bf16_f32 v139, v70, v71
    ds_bpermute_b32 v140, v22, v136
    ds_bpermute_b32 v141, v22, v137
    ds_bpermute_b32 v142, v22, v138
    ds_bpermute_b32 v143, v22, v139
    s_waitcnt vmcnt(6)
    v_cvt_f32_i32 v72, v72
    v_cvt_f32_i32 v73, v73
    v_cvt_f32_i32 v74, v74
    v_cvt_f32_i32 v75, v75
    v_cvt_f32_i32 v76, v76
    v_cvt_f32_i32 v77, v77
    v_cvt_f32_i32 v78, v78
    v_cvt_f32_i32 v79, v79
    v_cvt_pk_bf16_f32 v132, v72, v73
    v_cvt_pk_bf16_f32 v133, v74, v75
    v_cvt_pk_bf16_f32 v134, v76, v77
    v_cvt_pk_bf16_f32 v135, v78, v79
    v_lshlrev_b32 v72, 16, v132
    v_and_b32 v73, 0xffff0000, v132
    v_lshlrev_b32 v74, 16, v133
    v_and_b32 v75, 0xffff0000, v133
    v_lshlrev_b32 v76, 16, v134
    v_and_b32 v77, 0xffff0000, v134
    v_lshlrev_b32 v78, 16, v135
    v_and_b32 v79, 0xffff0000, v135
    v_pk_add_f32 v[72:73], v[72:73], v[120:121] neg_lo:[0,1] neg_hi:[0,1]
    v_pk_add_f32 v[74:75], v[74:75], v[122:123] neg_lo:[0,1] neg_hi:[0,1]
    v_pk_add_f32 v[76:77], v[76:77], v[124:125] neg_lo:[0,1] neg_hi:[0,1]
    v_pk_add_f32 v[78:79], v[78:79], v[126:127] neg_lo:[0,1] neg_hi:[0,1]
    v_cvt_pk_bf16_f32 v132, v72, v73
    v_cvt_pk_bf16_f32 v133, v74, v75
    v_cvt_pk_bf16_f32 v134, v76, v77
    v_cvt_pk_bf16_f32 v135, v78, v79
    v_lshlrev_b32 v72, 16, v132
    v_and_b32 v73, 0xffff0000, v132
    v_lshlrev_b32 v74, 16, v133
    v_and_b32 v75, 0xffff0000, v133
    v_lshlrev_b32 v76, 16, v134
    v_and_b32 v77, 0xffff0000, v134
    v_lshlrev_b32 v78, 16, v135
    v_and_b32 v79, 0xffff0000, v135
    v_pk_mul_f32 v[72:73], v[72:73], v[112:113]
    v_pk_mul_f32 v[74:75], v[74:75], v[114:115]
    v_pk_mul_f32 v[76:77], v[76:77], v[116:117]
    v_pk_mul_f32 v[78:79], v[78:79], v[118:119]
    v_cvt_pk_bf16_f32 v144, v72, v73
    v_cvt_pk_bf16_f32 v145, v74, v75
    v_cvt_pk_bf16_f32 v146, v76, v77
    v_cvt_pk_bf16_f32 v147, v78, v79
    s_waitcnt lgkmcnt(0)
    buffer_store_dwordx4 v[140:143], v26, s[12:15], s40 offen offset:0 sc1
    ds_bpermute_b32 v148, v22, v144
    ds_bpermute_b32 v149, v22, v145
    ds_bpermute_b32 v150, v22, v146
    ds_bpermute_b32 v151, v22, v147
    s_waitcnt vmcnt(3)
    v_cvt_f32_i32 v80, v80
    v_cvt_f32_i32 v81, v81
    v_cvt_f32_i32 v82, v82
    v_cvt_f32_i32 v83, v83
    v_cvt_f32_i32 v84, v84
    v_cvt_f32_i32 v85, v85
    v_cvt_f32_i32 v86, v86
    v_cvt_f32_i32 v87, v87
    v_cvt_pk_bf16_f32 v128, v80, v81
    v_cvt_pk_bf16_f32 v129, v82, v83
    v_cvt_pk_bf16_f32 v130, v84, v85
    v_cvt_pk_bf16_f32 v131, v86, v87
    v_lshlrev_b32 v120, 16, v108
    v_and_b32 v121, 0xffff0000, v108
    v_lshlrev_b32 v122, 16, v109
    v_and_b32 v123, 0xffff0000, v109
    v_lshlrev_b32 v124, 16, v110
    v_and_b32 v125, 0xffff0000, v110
    v_lshlrev_b32 v126, 16, v111
    v_and_b32 v127, 0xffff0000, v111
    v_lshlrev_b32 v80, 16, v128
    v_and_b32 v81, 0xffff0000, v128
    v_lshlrev_b32 v82, 16, v129
    v_and_b32 v83, 0xffff0000, v129
    v_lshlrev_b32 v84, 16, v130
    v_and_b32 v85, 0xffff0000, v130
    v_lshlrev_b32 v86, 16, v131
    v_and_b32 v87, 0xffff0000, v131
    v_pk_add_f32 v[80:81], v[80:81], v[120:121] neg_lo:[0,1] neg_hi:[0,1]
    v_pk_add_f32 v[82:83], v[82:83], v[122:123] neg_lo:[0,1] neg_hi:[0,1]
    v_pk_add_f32 v[84:85], v[84:85], v[124:125] neg_lo:[0,1] neg_hi:[0,1]
    v_pk_add_f32 v[86:87], v[86:87], v[126:127] neg_lo:[0,1] neg_hi:[0,1]
    v_cvt_pk_bf16_f32 v128, v80, v81
    v_cvt_pk_bf16_f32 v129, v82, v83
    v_cvt_pk_bf16_f32 v130, v84, v85
    v_cvt_pk_bf16_f32 v131, v86, v87
    v_lshlrev_b32 v112, 16, v104
    v_and_b32 v113, 0xffff0000, v104
    v_lshlrev_b32 v114, 16, v105
    v_and_b32 v115, 0xffff0000, v105
    v_lshlrev_b32 v116, 16, v106
    v_and_b32 v117, 0xffff0000, v106
    v_lshlrev_b32 v118, 16, v107
    v_and_b32 v119, 0xffff0000, v107
    v_lshlrev_b32 v80, 16, v128
    v_and_b32 v81, 0xffff0000, v128
    v_lshlrev_b32 v82, 16, v129
    v_and_b32 v83, 0xffff0000, v129
    v_lshlrev_b32 v84, 16, v130
    v_and_b32 v85, 0xffff0000, v130
    v_lshlrev_b32 v86, 16, v131
    v_and_b32 v87, 0xffff0000, v131
    v_pk_mul_f32 v[80:81], v[80:81], v[112:113]
    v_pk_mul_f32 v[82:83], v[82:83], v[114:115]
    v_pk_mul_f32 v[84:85], v[84:85], v[116:117]
    v_pk_mul_f32 v[86:87], v[86:87], v[118:119]
    v_cvt_pk_bf16_f32 v152, v80, v81
    v_cvt_pk_bf16_f32 v153, v82, v83
    v_cvt_pk_bf16_f32 v154, v84, v85
    v_cvt_pk_bf16_f32 v155, v86, v87
    s_waitcnt lgkmcnt(0)
    buffer_store_dwordx4 v[148:151], v26, s[12:15], s40 offen offset:256 sc1
    ds_bpermute_b32 v156, v22, v152
    ds_bpermute_b32 v157, v22, v153
    ds_bpermute_b32 v158, v22, v154
    ds_bpermute_b32 v159, v22, v155
    s_waitcnt vmcnt(2)
    v_cvt_f32_i32 v88, v88
    v_cvt_f32_i32 v89, v89
    v_cvt_f32_i32 v90, v90
    v_cvt_f32_i32 v91, v91
    v_cvt_f32_i32 v92, v92
    v_cvt_f32_i32 v93, v93
    v_cvt_f32_i32 v94, v94
    v_cvt_f32_i32 v95, v95
    v_cvt_pk_bf16_f32 v132, v88, v89
    v_cvt_pk_bf16_f32 v133, v90, v91
    v_cvt_pk_bf16_f32 v134, v92, v93
    v_cvt_pk_bf16_f32 v135, v94, v95
    v_lshlrev_b32 v88, 16, v132
    v_and_b32 v89, 0xffff0000, v132
    v_lshlrev_b32 v90, 16, v133
    v_and_b32 v91, 0xffff0000, v133
    v_lshlrev_b32 v92, 16, v134
    v_and_b32 v93, 0xffff0000, v134
    v_lshlrev_b32 v94, 16, v135
    v_and_b32 v95, 0xffff0000, v135
    v_pk_add_f32 v[88:89], v[88:89], v[120:121] neg_lo:[0,1] neg_hi:[0,1]
    v_pk_add_f32 v[90:91], v[90:91], v[122:123] neg_lo:[0,1] neg_hi:[0,1]
    v_pk_add_f32 v[92:93], v[92:93], v[124:125] neg_lo:[0,1] neg_hi:[0,1]
    v_pk_add_f32 v[94:95], v[94:95], v[126:127] neg_lo:[0,1] neg_hi:[0,1]
    v_cvt_pk_bf16_f32 v132, v88, v89
    v_cvt_pk_bf16_f32 v133, v90, v91
    v_cvt_pk_bf16_f32 v134, v92, v93
    v_cvt_pk_bf16_f32 v135, v94, v95
    v_lshlrev_b32 v88, 16, v132
    v_and_b32 v89, 0xffff0000, v132
    v_lshlrev_b32 v90, 16, v133
    v_and_b32 v91, 0xffff0000, v133
    v_lshlrev_b32 v92, 16, v134
    v_and_b32 v93, 0xffff0000, v134
    v_lshlrev_b32 v94, 16, v135
    v_and_b32 v95, 0xffff0000, v135
    v_pk_mul_f32 v[88:89], v[88:89], v[112:113]
    v_pk_mul_f32 v[90:91], v[90:91], v[114:115]
    v_pk_mul_f32 v[92:93], v[92:93], v[116:117]
    v_pk_mul_f32 v[94:95], v[94:95], v[118:119]
    v_cvt_pk_bf16_f32 v160, v88, v89
    v_cvt_pk_bf16_f32 v161, v90, v91
    v_cvt_pk_bf16_f32 v162, v92, v93
    v_cvt_pk_bf16_f32 v163, v94, v95
    s_waitcnt lgkmcnt(0)
    buffer_store_dwordx4 v[156:159], v26, s[12:15], s41 offen offset:0 sc1
    ds_bpermute_b32 v164, v22, v160
    ds_bpermute_b32 v165, v22, v161
    ds_bpermute_b32 v166, v22, v162
    ds_bpermute_b32 v167, v22, v163
    s_waitcnt lgkmcnt(0)
    buffer_store_dwordx4 v[164:167], v26, s[12:15], s41 offen offset:256 sc1
    s_add_u32 m0, s26, 24576
    s_nop 0
    buffer_load_dwordx4 v16, s[20:23], s24 offen offset:0 lds
    buffer_load_dwordx4 v17, s[20:23], s24 offen offset:1024 lds
    buffer_load_dwordx4 v18, s[20:23], s24 offen offset:2048 lds
    buffer_load_dwordx4 v19, s[20:23], s24 offen offset:3072 lds
    s_add_u32 s24, s24, 442368
    s_add_u32 s28, s28, 1
    s_cmp_eq_u32 s28, 14
    s_cselect_b32 s93, 6193152, 0
    s_sub_u32 s24, s24, s93
    s_add_u32 m0, s26, 28672
    s_nop 0
    buffer_load_dwordx4 v16, s[20:23], s24 offen offset:0 lds
    buffer_load_dwordx4 v17, s[20:23], s24 offen offset:1024 lds
    buffer_load_dwordx4 v18, s[20:23], s24 offen offset:2048 lds
    buffer_load_dwordx4 v19, s[20:23], s24 offen offset:3072 lds
    s_add_u32 s24, s24, 442368
    s_add_u32 s28, s28, 1
    s_cmp_eq_u32 s28, 14
    s_cselect_b32 s93, 6193152, 0
    s_sub_u32 s24, s24, s93
    s_add_u32 m0, s26, 32768
    s_nop 0
    buffer_load_dwordx4 v16, s[20:23], s24 offen offset:0 lds
    buffer_load_dwordx4 v17, s[20:23], s24 offen offset:1024 lds
    buffer_load_dwordx4 v18, s[20:23], s24 offen offset:2048 lds
    buffer_load_dwordx4 v19, s[20:23], s24 offen offset:3072 lds
    s_add_u32 s24, s24, 442368
    s_add_u32 s28, s28, 1
    s_cmp_eq_u32 s28, 14
    s_cselect_b32 s93, 6193152, 0
    s_sub_u32 s24, s24, s93
    s_add_u32 m0, s26, 36864
    s_nop 0
    buffer_load_dwordx4 v16, s[20:23], s24 offen offset:0 lds
    buffer_load_dwordx4 v17, s[20:23], s24 offen offset:1024 lds
    buffer_load_dwordx4 v18, s[20:23], s24 offen offset:2048 lds
    buffer_load_dwordx4 v19, s[20:23], s24 offen offset:3072 lds
    s_add_u32 s24, s24, 442368
    s_add_u32 s28, s28, 1
    s_cmp_eq_u32 s28, 14
    s_cselect_b32 s93, 6193152, 0
    s_sub_u32 s24, s24, s93
    s_waitcnt vmcnt(16)
    s_branch standalone__weight_only_int_quip__prompt_kernel_publish2
standalone__weight_only_int_quip__prompt_kernel_loader1:
    s_waitcnt lgkmcnt(0)
    s_add_u32 s32, s60, 7159808
    s_addc_u32 s33, s61, 0
    s_mov_b32 s34, 150784
    s_mov_b32 s35, 0x20000
    s_load_dword s39, s[32:33], 99328
    s_mov_b32 s20, s54
    s_mov_b32 s21, s55
    s_mov_b32 s22, 5971968
    s_mov_b32 s23, 0x20000
    v_lshrrev_b32 v3, 3, v2
    v_and_b32 v4, 7, v2
    v_bfe_u32 v5, v2, 4, 1
    v_lshlrev_b32 v5, 2, v5
    v_xor_b32 v4, v4, v5
    v_mul_u32_u24 v3, 3456, v3
    v_lshl_add_u32 v16, v4, 4, v3
    v_add_u32 v17, 26624, v16
    v_add_u32 v18, 53248, v16
    v_add_u32 v19, 79872, v16
    s_lshl_b32 s24, s6, 7
    s_mul_i32 s26, s3, 40960
    s_mul_i32 s99, s7, 1

    s_add_u32 s28, s99, 0
    s_cmp_ge_u32 s28, 14
    s_cselect_b32 s92, 14, 0
    s_sub_u32 s28, s28, s92
    s_mul_i32 s92, s28, 442368
    s_add_u32 s24, s24, s92

    s_mul_i32 s27, s7, 54
    s_add_u32 s27, s27, s3
    s_mul_i32 s27, s27, 6144
    s_cmp_ge_u32 s3, 2
    s_cselect_b32 s30, 13, 99
    v_lshlrev_b32 v20, 4, v2
    s_lshr_b32 s92, s3, 1
    s_lshl_b32 s92, s92, 8
    v_xor_b32 v21, s92, v20
    v_add_u32 v27, 4096, v21
    v_add_u32 v23, s26, v20
    v_lshrrev_b32 v3, 5, v2
    v_bfe_u32 v4, v2, 2, 2
    v_lshl_add_u32 v4, v3, 3, v4
    v_lshlrev_b32 v4, 7, v4
    v_bfe_u32 v5, v2, 4, 1
    v_lshl_add_u32 v4, v5, 5, v4
    v_and_b32 v5, 3, v2
    v_lshl_add_u32 v4, v5, 3, v4
    v_add_u32 v4, s26, v4
    v_bfe_u32 v5, v2, 3, 1
    v_lshl_add_u32 v24, v5, 6, v4
    s_and_b32 s92, s3, 1
    s_lshl_b32 s92, s92, 6
    v_xor_b32 v24, s92, v24
    v_xor_b32 v25, 64, v24
    s_mul_i32 s92, s7, 27
    v_add_u32 v28, s92, v2
    v_lshlrev_b32 v28, 8, v28
    s_lshl_b32 s93, s6, 3
    s_add_u32 s93, s93, 102400
    v_add_u32 v28, s93, v28
    s_add_u32 s92, s92, s6
    s_lshl_b32 s92, s92, 8
    s_add_u32 s92, s92, 102400
    v_min_u32 v29, 26, v2
    v_lshl_add_u32 v29, v29, 3, s92

    s_mov_b32 s12, s60
    s_mov_b32 s13, s61
    s_mov_b32 s14, 2322432
    s_mov_b32 s15, 0x20000
    s_add_u32 s16, s60, 2326528
    s_addc_u32 s17, s61, 0
    s_mov_b32 s18, 2211840
    s_mov_b32 s19, 0x20000
    s_waitcnt lgkmcnt(0)
    s_mul_i32 s38, s39, 0x9E3779B1
    s_add_u32 s38, s38, 0x7F4A7C15
    s_xor_b32 s39, s38, 0x5BD1E995

    s_add_u32 s92, s24, 0
    s_mov_b32 m0, 0
    s_nop 0
    buffer_load_dwordx4 v16, s[20:23], s92 offen offset:0 lds
    buffer_load_dwordx4 v17, s[20:23], s92 offen offset:1024 lds
    buffer_load_dwordx4 v18, s[20:23], s92 offen offset:2048 lds
    buffer_load_dwordx4 v19, s[20:23], s92 offen offset:3072 lds
    s_add_u32 s92, s24, 110592
    s_mov_b32 m0, 40960
    s_nop 0
    buffer_load_dwordx4 v16, s[20:23], s92 offen offset:0 lds
    buffer_load_dwordx4 v17, s[20:23], s92 offen offset:1024 lds
    buffer_load_dwordx4 v18, s[20:23], s92 offen offset:2048 lds
    buffer_load_dwordx4 v19, s[20:23], s92 offen offset:3072 lds
    s_add_u32 s92, s24, 221184
    s_mov_b32 m0, 81920
    s_nop 0
    buffer_load_dwordx4 v16, s[20:23], s92 offen offset:0 lds
    buffer_load_dwordx4 v17, s[20:23], s92 offen offset:1024 lds
    buffer_load_dwordx4 v18, s[20:23], s92 offen offset:2048 lds
    buffer_load_dwordx4 v19, s[20:23], s92 offen offset:3072 lds
    s_add_u32 s92, s24, 331776
    s_mov_b32 m0, 122880
    s_nop 0
    buffer_load_dwordx4 v16, s[20:23], s92 offen offset:0 lds
    buffer_load_dwordx4 v17, s[20:23], s92 offen offset:1024 lds
    buffer_load_dwordx4 v18, s[20:23], s92 offen offset:2048 lds
    buffer_load_dwordx4 v19, s[20:23], s92 offen offset:3072 lds
    s_add_u32 s24, s24, 442368
    s_add_u32 s28, s28, 1
    s_cmp_eq_u32 s28, 14
    s_cselect_b32 s93, 6193152, 0
    s_sub_u32 s24, s24, s93
    s_add_u32 s92, s24, 0
    s_mov_b32 m0, 4096
    s_nop 0
    buffer_load_dwordx4 v16, s[20:23], s92 offen offset:0 lds
    buffer_load_dwordx4 v17, s[20:23], s92 offen offset:1024 lds
    buffer_load_dwordx4 v18, s[20:23], s92 offen offset:2048 lds
    buffer_load_dwordx4 v19, s[20:23], s92 offen offset:3072 lds
    s_add_u32 s92, s24, 110592
    s_mov_b32 m0, 45056
    s_nop 0
    buffer_load_dwordx4 v16, s[20:23], s92 offen offset:0 lds
    buffer_load_dwordx4 v17, s[20:23], s92 offen offset:1024 lds
    buffer_load_dwordx4 v18, s[20:23], s92 offen offset:2048 lds
    buffer_load_dwordx4 v19, s[20:23], s92 offen offset:3072 lds
    s_add_u32 s92, s24, 221184
    s_mov_b32 m0, 86016
    s_nop 0
    buffer_load_dwordx4 v16, s[20:23], s92 offen offset:0 lds
    buffer_load_dwordx4 v17, s[20:23], s92 offen offset:1024 lds
    buffer_load_dwordx4 v18, s[20:23], s92 offen offset:2048 lds
    buffer_load_dwordx4 v19, s[20:23], s92 offen offset:3072 lds
    s_add_u32 s92, s24, 331776
    s_mov_b32 m0, 126976
    s_nop 0
    buffer_load_dwordx4 v16, s[20:23], s92 offen offset:0 lds
    buffer_load_dwordx4 v17, s[20:23], s92 offen offset:1024 lds
    buffer_load_dwordx4 v18, s[20:23], s92 offen offset:2048 lds
    buffer_load_dwordx4 v19, s[20:23], s92 offen offset:3072 lds
    s_add_u32 s24, s24, 442368
    s_add_u32 s28, s28, 1
    s_cmp_eq_u32 s28, 14
    s_cselect_b32 s93, 6193152, 0
    s_sub_u32 s24, s24, s93
    s_add_u32 s92, s24, 0
    s_mov_b32 m0, 8192
    s_nop 0
    buffer_load_dwordx4 v16, s[20:23], s92 offen offset:0 lds
    buffer_load_dwordx4 v17, s[20:23], s92 offen offset:1024 lds
    buffer_load_dwordx4 v18, s[20:23], s92 offen offset:2048 lds
    buffer_load_dwordx4 v19, s[20:23], s92 offen offset:3072 lds
    s_add_u32 s92, s24, 110592
    s_mov_b32 m0, 49152
    s_nop 0
    buffer_load_dwordx4 v16, s[20:23], s92 offen offset:0 lds
    buffer_load_dwordx4 v17, s[20:23], s92 offen offset:1024 lds
    buffer_load_dwordx4 v18, s[20:23], s92 offen offset:2048 lds
    buffer_load_dwordx4 v19, s[20:23], s92 offen offset:3072 lds
    s_add_u32 s92, s24, 221184
    s_mov_b32 m0, 90112
    s_nop 0
    buffer_load_dwordx4 v16, s[20:23], s92 offen offset:0 lds
    buffer_load_dwordx4 v17, s[20:23], s92 offen offset:1024 lds
    buffer_load_dwordx4 v18, s[20:23], s92 offen offset:2048 lds
    buffer_load_dwordx4 v19, s[20:23], s92 offen offset:3072 lds
    s_add_u32 s92, s24, 331776
    s_mov_b32 m0, 131072
    s_nop 0
    buffer_load_dwordx4 v16, s[20:23], s92 offen offset:0 lds
    buffer_load_dwordx4 v17, s[20:23], s92 offen offset:1024 lds
    buffer_load_dwordx4 v18, s[20:23], s92 offen offset:2048 lds
    buffer_load_dwordx4 v19, s[20:23], s92 offen offset:3072 lds
    s_add_u32 s24, s24, 442368
    s_add_u32 s28, s28, 1
    s_cmp_eq_u32 s28, 14
    s_cselect_b32 s93, 6193152, 0
    s_sub_u32 s24, s24, s93
    s_add_u32 s92, s24, 0
    s_mov_b32 m0, 12288
    s_nop 0
    buffer_load_dwordx4 v16, s[20:23], s92 offen offset:0 lds
    buffer_load_dwordx4 v17, s[20:23], s92 offen offset:1024 lds
    buffer_load_dwordx4 v18, s[20:23], s92 offen offset:2048 lds
    buffer_load_dwordx4 v19, s[20:23], s92 offen offset:3072 lds
    s_add_u32 s92, s24, 110592
    s_mov_b32 m0, 53248
    s_nop 0
    buffer_load_dwordx4 v16, s[20:23], s92 offen offset:0 lds
    buffer_load_dwordx4 v17, s[20:23], s92 offen offset:1024 lds
    buffer_load_dwordx4 v18, s[20:23], s92 offen offset:2048 lds
    buffer_load_dwordx4 v19, s[20:23], s92 offen offset:3072 lds
    s_add_u32 s92, s24, 221184
    s_mov_b32 m0, 94208
    s_nop 0
    buffer_load_dwordx4 v16, s[20:23], s92 offen offset:0 lds
    buffer_load_dwordx4 v17, s[20:23], s92 offen offset:1024 lds
    buffer_load_dwordx4 v18, s[20:23], s92 offen offset:2048 lds
    buffer_load_dwordx4 v19, s[20:23], s92 offen offset:3072 lds
    s_add_u32 s92, s24, 331776
    s_mov_b32 m0, 135168
    s_waitcnt vmcnt(56)
    buffer_load_dwordx4 v16, s[20:23], s92 offen offset:0 lds
    buffer_load_dwordx4 v17, s[20:23], s92 offen offset:1024 lds
    buffer_load_dwordx4 v18, s[20:23], s92 offen offset:2048 lds
    buffer_load_dwordx4 v19, s[20:23], s92 offen offset:3072 lds
    s_add_u32 s24, s24, 442368
    s_add_u32 s28, s28, 1
    s_cmp_eq_u32 s28, 14
    s_cselect_b32 s93, 6193152, 0
    s_sub_u32 s24, s24, s93
    s_add_u32 s92, s24, 0
    s_mov_b32 m0, 16384
    s_waitcnt vmcnt(56)
    buffer_load_dwordx4 v16, s[20:23], s92 offen offset:0 lds
    buffer_load_dwordx4 v17, s[20:23], s92 offen offset:1024 lds
    buffer_load_dwordx4 v18, s[20:23], s92 offen offset:2048 lds
    buffer_load_dwordx4 v19, s[20:23], s92 offen offset:3072 lds
    s_add_u32 s92, s24, 110592
    s_mov_b32 m0, 57344
    s_waitcnt vmcnt(56)
    buffer_load_dwordx4 v16, s[20:23], s92 offen offset:0 lds
    buffer_load_dwordx4 v17, s[20:23], s92 offen offset:1024 lds
    buffer_load_dwordx4 v18, s[20:23], s92 offen offset:2048 lds
    buffer_load_dwordx4 v19, s[20:23], s92 offen offset:3072 lds
    s_add_u32 s92, s24, 221184
    s_mov_b32 m0, 98304
    s_waitcnt vmcnt(56)
    buffer_load_dwordx4 v16, s[20:23], s92 offen offset:0 lds
    buffer_load_dwordx4 v17, s[20:23], s92 offen offset:1024 lds
    buffer_load_dwordx4 v18, s[20:23], s92 offen offset:2048 lds
    buffer_load_dwordx4 v19, s[20:23], s92 offen offset:3072 lds
    s_add_u32 s92, s24, 331776
    s_mov_b32 m0, 139264
    s_waitcnt vmcnt(56)
    buffer_load_dwordx4 v16, s[20:23], s92 offen offset:0 lds
    buffer_load_dwordx4 v17, s[20:23], s92 offen offset:1024 lds
    buffer_load_dwordx4 v18, s[20:23], s92 offen offset:2048 lds
    buffer_load_dwordx4 v19, s[20:23], s92 offen offset:3072 lds
    s_add_u32 s24, s24, 442368
    s_add_u32 s28, s28, 1
    s_cmp_eq_u32 s28, 14
    s_cselect_b32 s93, 6193152, 0
    s_sub_u32 s24, s24, s93
    s_add_u32 s92, s24, 0
    s_mov_b32 m0, 20480
    s_waitcnt vmcnt(56)
    buffer_load_dwordx4 v16, s[20:23], s92 offen offset:0 lds
    buffer_load_dwordx4 v17, s[20:23], s92 offen offset:1024 lds
    buffer_load_dwordx4 v18, s[20:23], s92 offen offset:2048 lds
    buffer_load_dwordx4 v19, s[20:23], s92 offen offset:3072 lds
    s_add_u32 s92, s24, 110592
    s_mov_b32 m0, 61440
    s_waitcnt vmcnt(56)
    buffer_load_dwordx4 v16, s[20:23], s92 offen offset:0 lds
    buffer_load_dwordx4 v17, s[20:23], s92 offen offset:1024 lds
    buffer_load_dwordx4 v18, s[20:23], s92 offen offset:2048 lds
    buffer_load_dwordx4 v19, s[20:23], s92 offen offset:3072 lds
    s_add_u32 s92, s24, 221184
    s_mov_b32 m0, 102400
    s_waitcnt vmcnt(56)
    buffer_load_dwordx4 v16, s[20:23], s92 offen offset:0 lds
    buffer_load_dwordx4 v17, s[20:23], s92 offen offset:1024 lds
    buffer_load_dwordx4 v18, s[20:23], s92 offen offset:2048 lds
    buffer_load_dwordx4 v19, s[20:23], s92 offen offset:3072 lds
    s_add_u32 s92, s24, 331776
    s_mov_b32 m0, 143360
    s_waitcnt vmcnt(56)
    buffer_load_dwordx4 v16, s[20:23], s92 offen offset:0 lds
    buffer_load_dwordx4 v17, s[20:23], s92 offen offset:1024 lds
    buffer_load_dwordx4 v18, s[20:23], s92 offen offset:2048 lds
    buffer_load_dwordx4 v19, s[20:23], s92 offen offset:3072 lds
    s_add_u32 s24, s24, 442368
    s_add_u32 s28, s28, 1
    s_cmp_eq_u32 s28, 14
    s_cselect_b32 s93, 6193152, 0
    s_sub_u32 s24, s24, s93
    s_add_u32 s24, s24, 331776
    s_waitcnt vmcnt(31)
    s_add_u32 m0, s26, 24576
    s_nop 0
    buffer_load_dwordx4 v16, s[20:23], s24 offen offset:0 lds
    buffer_load_dwordx4 v17, s[20:23], s24 offen offset:1024 lds
    buffer_load_dwordx4 v18, s[20:23], s24 offen offset:2048 lds
    buffer_load_dwordx4 v19, s[20:23], s24 offen offset:3072 lds
    s_add_u32 s24, s24, 442368
    s_add_u32 s28, s28, 1
    s_cmp_eq_u32 s28, 14
    s_cselect_b32 s93, 6193152, 0
    s_sub_u32 s24, s24, s93
    s_add_u32 m0, s26, 28672
    s_nop 0
    buffer_load_dwordx4 v16, s[20:23], s24 offen offset:0 lds
    buffer_load_dwordx4 v17, s[20:23], s24 offen offset:1024 lds
    buffer_load_dwordx4 v18, s[20:23], s24 offen offset:2048 lds
    buffer_load_dwordx4 v19, s[20:23], s24 offen offset:3072 lds
    s_add_u32 s24, s24, 442368
    s_add_u32 s28, s28, 1
    s_cmp_eq_u32 s28, 14
    s_cselect_b32 s93, 6193152, 0
    s_sub_u32 s24, s24, s93
    s_add_u32 m0, s26, 32768
    s_nop 0
    buffer_load_dwordx4 v16, s[20:23], s24 offen offset:0 lds
    buffer_load_dwordx4 v17, s[20:23], s24 offen offset:1024 lds
    buffer_load_dwordx4 v18, s[20:23], s24 offen offset:2048 lds
    buffer_load_dwordx4 v19, s[20:23], s24 offen offset:3072 lds
    s_add_u32 s24, s24, 442368
    s_add_u32 s28, s28, 1
    s_cmp_eq_u32 s28, 14
    s_cselect_b32 s93, 6193152, 0
    s_sub_u32 s24, s24, s93
    s_add_u32 m0, s26, 36864
    s_nop 0
    buffer_load_dwordx4 v16, s[20:23], s24 offen offset:0 lds
    buffer_load_dwordx4 v17, s[20:23], s24 offen offset:1024 lds
    buffer_load_dwordx4 v18, s[20:23], s24 offen offset:2048 lds
    buffer_load_dwordx4 v19, s[20:23], s24 offen offset:3072 lds
    s_add_u32 s24, s24, 442368
    s_add_u32 s28, s28, 1
    s_cmp_eq_u32 s28, 14
    s_cselect_b32 s93, 6193152, 0
    s_sub_u32 s24, s24, s93
standalone__weight_only_int_quip__prompt_kernel_publish2:
    s_barrier
    s_cmp_lg_u32 s3, 0
    s_cbranch_scc1 standalone__weight_only_int_quip__prompt_kernel_pub3
    v_mov_b32 v30, s38
    v_mov_b32 v31, s39
    s_mov_b64 exec, 0x7ffffff
    buffer_store_dwordx2 v[30:31], v28, s[32:35], 0 offen offset:0 sc1
    s_mov_b64 exec, -1
standalone__weight_only_int_quip__prompt_kernel_pub3:

    buffer_load_dwordx4 a[192:195], v16, s[20:23], s24 offen offset:0
    buffer_load_dwordx4 a[196:199], v17, s[20:23], s24 offen offset:1024
    buffer_load_dwordx4 a[200:203], v18, s[20:23], s24 offen offset:2048
    buffer_load_dwordx4 a[204:207], v19, s[20:23], s24 offen offset:3072
    s_add_u32 s24, s24, 442368
    s_add_u32 s28, s28, 1
    s_cmp_eq_u32 s28, 14
    s_cselect_b32 s93, 6193152, 0
    s_sub_u32 s24, s24, s93
    buffer_load_dwordx4 a[208:211], v16, s[20:23], s24 offen offset:0
    buffer_load_dwordx4 a[212:215], v17, s[20:23], s24 offen offset:1024
    buffer_load_dwordx4 a[216:219], v18, s[20:23], s24 offen offset:2048
    buffer_load_dwordx4 a[220:223], v19, s[20:23], s24 offen offset:3072
    s_add_u32 s24, s24, 442368
    s_add_u32 s28, s28, 1
    s_cmp_eq_u32 s28, 14
    s_cselect_b32 s93, 6193152, 0
    s_sub_u32 s24, s24, s93
    buffer_load_dwordx4 a[224:227], v16, s[20:23], s24 offen offset:0
    buffer_load_dwordx4 a[228:231], v17, s[20:23], s24 offen offset:1024
    buffer_load_dwordx4 a[232:235], v18, s[20:23], s24 offen offset:2048
    buffer_load_dwordx4 a[236:239], v19, s[20:23], s24 offen offset:3072
    s_add_u32 s24, s24, 442368
    s_add_u32 s28, s28, 1
    s_cmp_eq_u32 s28, 14
    s_cselect_b32 s93, 6193152, 0
    s_sub_u32 s24, s24, s93
    buffer_load_dwordx4 a[240:243], v16, s[20:23], s24 offen offset:0
    buffer_load_dwordx4 a[244:247], v17, s[20:23], s24 offen offset:1024
    buffer_load_dwordx4 a[248:251], v18, s[20:23], s24 offen offset:2048
    buffer_load_dwordx4 a[252:255], v19, s[20:23], s24 offen offset:3072
    s_add_u32 s24, s24, 442368
    s_add_u32 s28, s28, 1
    s_cmp_eq_u32 s28, 14
    s_cselect_b32 s93, 6193152, 0
    s_sub_u32 s24, s24, s93
    s_cmp_lg_u32 s3, 0
    s_cbranch_scc1 standalone__weight_only_int_quip__prompt_kernel_pd4
    s_mov_b32 s37, 0
    buffer_load_dwordx2 v[8:9], v29, s[32:35], 0 offen sc1
    s_sleep 1
    buffer_load_dwordx2 v[10:11], v29, s[32:35], 0 offen sc1
    s_sleep 1
    buffer_load_dwordx2 v[12:13], v29, s[32:35], 0 offen sc1
    s_sleep 1
standalone__weight_only_int_quip__prompt_kernel_pl5:
    buffer_load_dwordx2 v[14:15], v29, s[32:35], 0 offen sc1
    s_waitcnt vmcnt(3)
    v_cmp_ne_u64 vcc, s[38:39], v[8:9]
    s_cbranch_vccz standalone__weight_only_int_quip__prompt_kernel_pd4
    s_sleep 1

    buffer_load_dwordx2 v[8:9], v29, s[32:35], 0 offen sc1
    s_waitcnt vmcnt(3)
    v_cmp_ne_u64 vcc, s[38:39], v[10:11]
    s_cbranch_vccz standalone__weight_only_int_quip__prompt_kernel_pd4
    s_sleep 1

    buffer_load_dwordx2 v[10:11], v29, s[32:35], 0 offen sc1
    s_waitcnt vmcnt(3)
    v_cmp_ne_u64 vcc, s[38:39], v[12:13]
    s_cbranch_vccz standalone__weight_only_int_quip__prompt_kernel_pd4
    s_sleep 1

    buffer_load_dwordx2 v[12:13], v29, s[32:35], 0 offen sc1
    s_waitcnt vmcnt(3)
    v_cmp_ne_u64 vcc, s[38:39], v[14:15]
    s_cbranch_vccz standalone__weight_only_int_quip__prompt_kernel_pd4
    s_sleep 1

    s_add_u32 s37, s37, 1
    s_cmp_lt_u32 s37, 524288
    s_cbranch_scc1 standalone__weight_only_int_quip__prompt_kernel_pl5

standalone__weight_only_int_quip__prompt_kernel_pd4:
    s_waitcnt vmcnt(0)
    s_barrier
    s_add_u32 s92, s99, 0
    s_cmp_ge_u32 s92, 14
    s_cselect_b32 s93, 14, 0
    s_sub_u32 s92, s92, s93
    s_mul_i32 s93, s92, 24576
    s_add_u32 s93, s93, s27
    s_cmp_eq_u32 s92, s30
    s_cselect_b32 s31, 2146435072, s93
    buffer_load_dwordx4 v[64:67], v21, s[12:15], s31 offen offset:0 sc1
    buffer_load_dwordx4 v[68:71], v21, s[12:15], s31 offen offset:1024 sc1
    buffer_load_dwordx4 v[72:75], v21, s[12:15], s31 offen offset:2048 sc1
    buffer_load_dwordx4 v[76:79], v21, s[12:15], s31 offen offset:3072 sc1
    s_add_u32 s92, s99, 1
    s_cmp_ge_u32 s92, 14
    s_cselect_b32 s93, 14, 0
    s_sub_u32 s92, s92, s93
    s_mul_i32 s93, s92, 24576
    s_add_u32 s93, s93, s27
    s_cmp_eq_u32 s92, s30
    s_cselect_b32 s31, 2146435072, s93
    buffer_load_dwordx4 v[80:83], v21, s[12:15], s31 offen offset:0 sc1
    buffer_load_dwordx4 v[84:87], v21, s[12:15], s31 offen offset:1024 sc1
    buffer_load_dwordx4 v[88:91], v21, s[12:15], s31 offen offset:2048 sc1
    buffer_load_dwordx4 v[92:95], v21, s[12:15], s31 offen offset:3072 sc1
    s_add_u32 s92, s99, 2
    s_cmp_ge_u32 s92, 14
    s_cselect_b32 s93, 14, 0
    s_sub_u32 s92, s92, s93
    s_mul_i32 s93, s92, 24576
    s_add_u32 s93, s93, s27
    s_cmp_eq_u32 s92, s30
    s_cselect_b32 s31, 2146435072, s93
    buffer_load_dwordx4 v[96:99], v21, s[12:15], s31 offen offset:0 sc1
    buffer_load_dwordx4 v[100:103], v21, s[12:15], s31 offen offset:1024 sc1
    buffer_load_dwordx4 v[104:107], v21, s[12:15], s31 offen offset:2048 sc1
    buffer_load_dwordx4 v[108:111], v21, s[12:15], s31 offen offset:3072 sc1
    s_add_u32 s92, s99, 3
    s_cmp_ge_u32 s92, 14
    s_cselect_b32 s93, 14, 0
    s_sub_u32 s92, s92, s93
    s_mul_i32 s93, s92, 24576
    s_add_u32 s93, s93, s27
    s_cmp_eq_u32 s92, s30
    s_cselect_b32 s31, 2146435072, s93
    buffer_load_dwordx4 v[112:115], v21, s[12:15], s31 offen offset:0 sc1
    buffer_load_dwordx4 v[116:119], v21, s[12:15], s31 offen offset:1024 sc1
    buffer_load_dwordx4 v[120:123], v21, s[12:15], s31 offen offset:2048 sc1
    buffer_load_dwordx4 v[124:127], v21, s[12:15], s31 offen offset:3072 sc1
    ds_read_b64_tr_b16 a[96:97], v24 offset:0
    ds_read_b64_tr_b16 a[98:99], v24 offset:512
    ds_read_b64_tr_b16 a[100:101], v25 offset:0
    ds_read_b64_tr_b16 a[102:103], v25 offset:512
    ds_read_b64_tr_b16 a[104:105], v24 offset:2048
    ds_read_b64_tr_b16 a[106:107], v24 offset:2560
    ds_read_b64_tr_b16 a[108:109], v25 offset:2048
    ds_read_b64_tr_b16 a[110:111], v25 offset:2560
    s_lshl_b32 s92, s62, 4
    s_add_u32 s92, s92, s63
    s_lshl_b32 s92, s92, 7
    s_add_u32 s92, s92, 65536
    v_and_b32 v29, 3, v2
    v_lshl_add_u32 v29, v29, 3, s92

    s_add_u32 s8, s60, 4538368
    s_addc_u32 s9, s61, 0
    s_mov_b32 s10, 2621440
    s_mov_b32 s11, 0x20000
    s_lshl_b32 s25, s63, 2
    s_add_u32 s25, s25, s3
    s_mul_i32 s25, s25, 40960
    v_lshlrev_b32 v20, 4, v2

    s_xor_b32 s92, s3, 1
    s_mul_i32 s92, s92, 40960
    v_add_u32 v4, s92, v20

    s_xor_b32 s92, s3, 2
    s_mul_i32 s92, s92, 40960
    v_add_u32 v5, s92, v20

    s_xor_b32 s92, s3, 3
    s_mul_i32 s92, s92, 40960
    v_add_u32 v6, s92, v20

    s_and_b32 s92, s3, 1
    s_lshl_b32 s93, s6, 1
    s_add_u32 s92, s92, s93
    s_mul_i32 s92, s92, 40
    s_lshr_b32 s93, s3, 1
    s_add_u32 s92, s92, s93
    s_lshl_b32 s93, s7, 2
    s_add_u32 s40, s92, s93
    s_lshl_b32 s40, s40, 10
    s_lshl_b32 s93, s7, 1
    s_add_u32 s92, s92, s93
    s_add_u32 s92, s92, 28
    s_lshl_b32 s92, s92, 10
    s_cmp_eq_u32 s7, 6
    s_cselect_b32 s41, 2146435072, s92
    s_lshr_b32 s92, s6, 1
    s_lshl_b32 s92, s92, 4
    v_add_u32 v28, s92, v2
    v_lshlrev_b32 v28, 8, v28
    s_lshl_b32 s92, s7, 1
    s_and_b32 s93, s6, 1
    s_add_u32 s92, s92, s93
    s_lshl_b32 s92, s92, 3
    s_add_u32 s92, s92, 0
    v_add_u32 v28, s92, v28

    s_waitcnt vmcnt(12)
    s_waitcnt lgkmcnt(0)
    v_mfma_f32_32x32x16_bf16 a[0:15], v[64:67], a[96:99], 0
    ds_read_b64_tr_b16 a[112:113], v24 offset:4096
    ds_read_b64_tr_b16 a[114:115], v24 offset:4608
    v_mfma_f32_32x32x16_bf16 a[16:31], v[64:67], a[100:103], 0
    ds_read_b64_tr_b16 a[116:117], v25 offset:4096
    ds_read_b64_tr_b16 a[118:119], v25 offset:4608
    s_add_u32 s92, s99, 4
    s_cmp_ge_u32 s92, 14
    s_cselect_b32 s93, 14, 0
    s_sub_u32 s92, s92, s93
    s_mul_i32 s93, s92, 24576
    s_add_u32 s93, s93, s27
    s_cmp_eq_u32 s92, s30
    s_cselect_b32 s31, 2146435072, s93
    buffer_load_dwordx4 v[128:131], v21, s[12:15], s31 offen offset:0 sc1
    v_mfma_f32_32x32x16_bf16 a[32:47], v[68:71], a[96:99], 0
    ds_read_b64_tr_b16 a[120:121], v24 offset:6144
    ds_read_b64_tr_b16 a[122:123], v24 offset:6656
    v_mfma_f32_32x32x16_bf16 a[48:63], v[68:71], a[100:103], 0
    ds_read_b64_tr_b16 a[124:125], v25 offset:6144
    ds_read_b64_tr_b16 a[126:127], v25 offset:6656
    buffer_load_dwordx4 v[132:135], v21, s[12:15], s31 offen offset:1024 sc1
    v_mfma_f32_32x32x16_bf16 a[0:15], v[72:75], a[104:107], a[0:15]
    ds_write_b128 v23, a[192:195] offset:0
    v_mfma_f32_32x32x16_bf16 a[16:31], v[72:75], a[108:111], a[16:31]
    ds_write_b128 v23, a[196:199] offset:1024
    buffer_load_dwordx4 v[136:139], v21, s[12:15], s31 offen offset:2048 sc1
    v_mfma_f32_32x32x16_bf16 a[32:47], v[76:79], a[104:107], a[32:47]
    ds_write_b128 v23, a[200:203] offset:2048
    v_mfma_f32_32x32x16_bf16 a[48:63], v[76:79], a[108:111], a[48:63]
    ds_write_b128 v23, a[204:207] offset:3072
    buffer_load_dwordx4 v[140:143], v21, s[12:15], s31 offen offset:3072 sc1
    s_waitcnt vmcnt(12)
    s_waitcnt lgkmcnt(0)
    v_mfma_f32_32x32x16_bf16 a[0:15], v[80:83], a[112:115], a[0:15]
    ds_read_b64_tr_b16 a[128:129], v24 offset:8192
    ds_read_b64_tr_b16 a[130:131], v24 offset:8704
    v_mfma_f32_32x32x16_bf16 a[16:31], v[80:83], a[116:119], a[16:31]
    ds_read_b64_tr_b16 a[132:133], v25 offset:8192
    ds_read_b64_tr_b16 a[134:135], v25 offset:8704
    s_add_u32 s92, s99, 5
    s_cmp_ge_u32 s92, 14
    s_cselect_b32 s93, 14, 0
    s_sub_u32 s92, s92, s93
    s_mul_i32 s93, s92, 24576
    s_add_u32 s93, s93, s27
    s_cmp_eq_u32 s92, s30
    s_cselect_b32 s31, 2146435072, s93
    buffer_load_dwordx4 v[144:147], v21, s[12:15], s31 offen offset:0 sc1
    v_mfma_f32_32x32x16_bf16 a[32:47], v[84:87], a[112:115], a[32:47]
    ds_read_b64_tr_b16 a[136:137], v24 offset:10240
    ds_read_b64_tr_b16 a[138:139], v24 offset:10752
    v_mfma_f32_32x32x16_bf16 a[48:63], v[84:87], a[116:119], a[48:63]
    ds_read_b64_tr_b16 a[140:141], v25 offset:10240
    ds_read_b64_tr_b16 a[142:143], v25 offset:10752
    buffer_load_dwordx4 v[148:151], v21, s[12:15], s31 offen offset:1024 sc1
    v_mfma_f32_32x32x16_bf16 a[0:15], v[88:91], a[120:123], a[0:15]
    ds_write_b128 v23, a[208:211] offset:4096
    v_mfma_f32_32x32x16_bf16 a[16:31], v[88:91], a[124:127], a[16:31]
    ds_write_b128 v23, a[212:215] offset:5120
    buffer_load_dwordx4 v[152:155], v21, s[12:15], s31 offen offset:2048 sc1
    v_mfma_f32_32x32x16_bf16 a[32:47], v[92:95], a[120:123], a[32:47]
    ds_write_b128 v23, a[216:219] offset:6144
    v_mfma_f32_32x32x16_bf16 a[48:63], v[92:95], a[124:127], a[48:63]
    ds_write_b128 v23, a[220:223] offset:7168
    buffer_load_dwordx4 v[156:159], v21, s[12:15], s31 offen offset:3072 sc1
    s_waitcnt vmcnt(12)
    s_waitcnt lgkmcnt(0)
    v_mfma_f32_32x32x16_bf16 a[0:15], v[96:99], a[128:131], a[0:15]
    ds_read_b64_tr_b16 a[144:145], v24 offset:12288
    ds_read_b64_tr_b16 a[146:147], v24 offset:12800
    v_mfma_f32_32x32x16_bf16 a[16:31], v[96:99], a[132:135], a[16:31]
    ds_read_b64_tr_b16 a[148:149], v25 offset:12288
    ds_read_b64_tr_b16 a[150:151], v25 offset:12800
    s_add_u32 s92, s99, 6
    s_cmp_ge_u32 s92, 14
    s_cselect_b32 s93, 14, 0
    s_sub_u32 s92, s92, s93
    s_mul_i32 s93, s92, 24576
    s_add_u32 s93, s93, s27
    s_cmp_eq_u32 s92, s30
    s_cselect_b32 s31, 2146435072, s93
    buffer_load_dwordx4 v[160:163], v21, s[12:15], s31 offen offset:0 sc1
    v_mfma_f32_32x32x16_bf16 a[32:47], v[100:103], a[128:131], a[32:47]
    ds_read_b64_tr_b16 a[152:153], v24 offset:14336
    ds_read_b64_tr_b16 a[154:155], v24 offset:14848
    v_mfma_f32_32x32x16_bf16 a[48:63], v[100:103], a[132:135], a[48:63]
    ds_read_b64_tr_b16 a[156:157], v25 offset:14336
    ds_read_b64_tr_b16 a[158:159], v25 offset:14848
    buffer_load_dwordx4 v[164:167], v21, s[12:15], s31 offen offset:1024 sc1
    v_mfma_f32_32x32x16_bf16 a[0:15], v[104:107], a[136:139], a[0:15]
    ds_write_b128 v23, a[224:227] offset:8192
    v_mfma_f32_32x32x16_bf16 a[16:31], v[104:107], a[140:143], a[16:31]
    ds_write_b128 v23, a[228:231] offset:9216
    buffer_load_dwordx4 v[168:171], v21, s[12:15], s31 offen offset:2048 sc1
    v_mfma_f32_32x32x16_bf16 a[32:47], v[108:111], a[136:139], a[32:47]
    ds_write_b128 v23, a[232:235] offset:10240
    v_mfma_f32_32x32x16_bf16 a[48:63], v[108:111], a[140:143], a[48:63]
    ds_write_b128 v23, a[236:239] offset:11264
    buffer_load_dwordx4 v[172:175], v21, s[12:15], s31 offen offset:3072 sc1
    s_waitcnt vmcnt(12)
    s_waitcnt lgkmcnt(0)
    v_mfma_f32_32x32x16_bf16 a[0:15], v[112:115], a[144:147], a[0:15]
    ds_read_b64_tr_b16 a[192:193], v24 offset:16384
    ds_read_b64_tr_b16 a[194:195], v24 offset:16896
    v_mfma_f32_32x32x16_bf16 a[16:31], v[112:115], a[148:151], a[16:31]
    ds_read_b64_tr_b16 a[196:197], v25 offset:16384
    ds_read_b64_tr_b16 a[198:199], v25 offset:16896
    s_add_u32 s92, s99, 7
    s_cmp_ge_u32 s92, 14
    s_cselect_b32 s93, 14, 0
    s_sub_u32 s92, s92, s93
    s_mul_i32 s93, s92, 24576
    s_add_u32 s93, s93, s27
    s_cmp_eq_u32 s92, s30
    s_cselect_b32 s31, 2146435072, s93
    buffer_load_dwordx4 v[176:179], v21, s[12:15], s31 offen offset:0 sc1
    v_mfma_f32_32x32x16_bf16 a[32:47], v[116:119], a[144:147], a[32:47]
    ds_read_b64_tr_b16 a[200:201], v24 offset:18432
    ds_read_b64_tr_b16 a[202:203], v24 offset:18944
    v_mfma_f32_32x32x16_bf16 a[48:63], v[116:119], a[148:151], a[48:63]
    ds_read_b64_tr_b16 a[204:205], v25 offset:18432
    ds_read_b64_tr_b16 a[206:207], v25 offset:18944
    buffer_load_dwordx4 v[180:183], v21, s[12:15], s31 offen offset:1024 sc1
    v_mfma_f32_32x32x16_bf16 a[0:15], v[120:123], a[152:155], a[0:15]
    ds_write_b128 v23, a[240:243] offset:12288
    v_mfma_f32_32x32x16_bf16 a[16:31], v[120:123], a[156:159], a[16:31]
    ds_write_b128 v23, a[244:247] offset:13312
    buffer_load_dwordx4 v[184:187], v21, s[12:15], s31 offen offset:2048 sc1
    v_mfma_f32_32x32x16_bf16 a[32:47], v[124:127], a[152:155], a[32:47]
    ds_write_b128 v23, a[248:251] offset:14336
    v_mfma_f32_32x32x16_bf16 a[48:63], v[124:127], a[156:159], a[48:63]
    ds_write_b128 v23, a[252:255] offset:15360
    buffer_load_dwordx4 v[188:191], v21, s[12:15], s31 offen offset:3072 sc1
    s_waitcnt vmcnt(12)
    s_waitcnt lgkmcnt(0)
    v_mfma_f32_32x32x16_bf16 a[0:15], v[128:131], a[192:195], a[0:15]
    ds_read_b64_tr_b16 a[208:209], v24 offset:20480
    ds_read_b64_tr_b16 a[210:211], v24 offset:20992
    v_mfma_f32_32x32x16_bf16 a[16:31], v[128:131], a[196:199], a[16:31]
    ds_read_b64_tr_b16 a[212:213], v25 offset:20480
    ds_read_b64_tr_b16 a[214:215], v25 offset:20992
    s_add_u32 s92, s99, 8
    s_cmp_ge_u32 s92, 14
    s_cselect_b32 s93, 14, 0
    s_sub_u32 s92, s92, s93
    s_mul_i32 s93, s92, 24576
    s_add_u32 s93, s93, s27
    s_cmp_eq_u32 s92, s30
    s_cselect_b32 s31, 2146435072, s93
    buffer_load_dwordx4 v[64:67], v21, s[12:15], s31 offen offset:0 sc1
    v_mfma_f32_32x32x16_bf16 a[32:47], v[132:135], a[192:195], a[32:47]
    ds_read_b64_tr_b16 a[216:217], v24 offset:22528
    ds_read_b64_tr_b16 a[218:219], v24 offset:23040
    v_mfma_f32_32x32x16_bf16 a[48:63], v[132:135], a[196:199], a[48:63]
    ds_read_b64_tr_b16 a[220:221], v25 offset:22528
    ds_read_b64_tr_b16 a[222:223], v25 offset:23040
    buffer_load_dwordx4 v[68:71], v21, s[12:15], s31 offen offset:1024 sc1
    v_mfma_f32_32x32x16_bf16 a[0:15], v[136:139], a[200:203], a[0:15]
    v_mfma_f32_32x32x16_bf16 a[16:31], v[136:139], a[204:207], a[16:31]
    buffer_load_dwordx4 v[72:75], v21, s[12:15], s31 offen offset:2048 sc1
    v_mfma_f32_32x32x16_bf16 a[32:47], v[140:143], a[200:203], a[32:47]
    v_mfma_f32_32x32x16_bf16 a[48:63], v[140:143], a[204:207], a[48:63]
    buffer_load_dwordx4 v[76:79], v21, s[12:15], s31 offen offset:3072 sc1
    s_waitcnt vmcnt(12)
    s_waitcnt lgkmcnt(0)
    v_mfma_f32_32x32x16_bf16 a[0:15], v[144:147], a[208:211], a[0:15]
    ds_read_b64_tr_b16 a[224:225], v24 offset:24576
    ds_read_b64_tr_b16 a[226:227], v24 offset:25088
    v_mfma_f32_32x32x16_bf16 a[16:31], v[144:147], a[212:215], a[16:31]
    ds_read_b64_tr_b16 a[228:229], v25 offset:24576
    ds_read_b64_tr_b16 a[230:231], v25 offset:25088
    s_add_u32 s92, s99, 9
    s_cmp_ge_u32 s92, 14
    s_cselect_b32 s93, 14, 0
    s_sub_u32 s92, s92, s93
    s_mul_i32 s93, s92, 24576
    s_add_u32 s93, s93, s27
    s_cmp_eq_u32 s92, s30
    s_cselect_b32 s31, 2146435072, s93
    buffer_load_dwordx4 v[80:83], v21, s[12:15], s31 offen offset:0 sc1
    v_mfma_f32_32x32x16_bf16 a[32:47], v[148:151], a[208:211], a[32:47]
    ds_read_b64_tr_b16 a[232:233], v24 offset:26624
    ds_read_b64_tr_b16 a[234:235], v24 offset:27136
    v_mfma_f32_32x32x16_bf16 a[48:63], v[148:151], a[212:215], a[48:63]
    ds_read_b64_tr_b16 a[236:237], v25 offset:26624
    ds_read_b64_tr_b16 a[238:239], v25 offset:27136
    buffer_load_dwordx4 v[84:87], v21, s[12:15], s31 offen offset:1024 sc1
    v_mfma_f32_32x32x16_bf16 a[0:15], v[152:155], a[216:219], a[0:15]
    v_mfma_f32_32x32x16_bf16 a[16:31], v[152:155], a[220:223], a[16:31]
    buffer_load_dwordx4 v[88:91], v21, s[12:15], s31 offen offset:2048 sc1
    v_mfma_f32_32x32x16_bf16 a[32:47], v[156:159], a[216:219], a[32:47]
    v_mfma_f32_32x32x16_bf16 a[48:63], v[156:159], a[220:223], a[48:63]
    buffer_load_dwordx4 v[92:95], v21, s[12:15], s31 offen offset:3072 sc1
    s_waitcnt vmcnt(12)
    s_waitcnt lgkmcnt(0)
    v_mfma_f32_32x32x16_bf16 a[0:15], v[160:163], a[224:227], a[0:15]
    ds_read_b64_tr_b16 v[48:49], v24 offset:28672
    ds_read_b64_tr_b16 v[50:51], v24 offset:29184
    v_mfma_f32_32x32x16_bf16 a[16:31], v[160:163], a[228:231], a[16:31]
    ds_read_b64_tr_b16 v[52:53], v25 offset:28672
    ds_read_b64_tr_b16 v[54:55], v25 offset:29184
    s_add_u32 s92, s99, 10
    s_cmp_ge_u32 s92, 14
    s_cselect_b32 s93, 14, 0
    s_sub_u32 s92, s92, s93
    s_mul_i32 s93, s92, 24576
    s_add_u32 s93, s93, s27
    s_cmp_eq_u32 s92, s30
    s_cselect_b32 s31, 2146435072, s93
    buffer_load_dwordx4 v[96:99], v21, s[12:15], s31 offen offset:0 sc1
    v_mfma_f32_32x32x16_bf16 a[32:47], v[164:167], a[224:227], a[32:47]
    ds_read_b64_tr_b16 v[56:57], v24 offset:30720
    ds_read_b64_tr_b16 v[58:59], v24 offset:31232
    v_mfma_f32_32x32x16_bf16 a[48:63], v[164:167], a[228:231], a[48:63]
    ds_read_b64_tr_b16 v[60:61], v25 offset:30720
    ds_read_b64_tr_b16 v[62:63], v25 offset:31232
    buffer_load_dwordx4 v[100:103], v21, s[12:15], s31 offen offset:1024 sc1
    v_mfma_f32_32x32x16_bf16 a[0:15], v[168:171], a[232:235], a[0:15]
    v_mfma_f32_32x32x16_bf16 a[16:31], v[168:171], a[236:239], a[16:31]
    buffer_load_dwordx4 v[104:107], v21, s[12:15], s31 offen offset:2048 sc1
    v_mfma_f32_32x32x16_bf16 a[32:47], v[172:175], a[232:235], a[32:47]
    v_mfma_f32_32x32x16_bf16 a[48:63], v[172:175], a[236:239], a[48:63]
    buffer_load_dwordx4 v[108:111], v21, s[12:15], s31 offen offset:3072 sc1
    s_waitcnt vmcnt(12)
    s_waitcnt lgkmcnt(0)
    v_mfma_f32_32x32x16_bf16 a[0:15], v[176:179], v[48:51], a[0:15]
    ds_read_b64_tr_b16 v[32:33], v24 offset:32768
    ds_read_b64_tr_b16 v[34:35], v24 offset:33280
    v_mfma_f32_32x32x16_bf16 a[16:31], v[176:179], v[52:55], a[16:31]
    ds_read_b64_tr_b16 v[36:37], v25 offset:32768
    ds_read_b64_tr_b16 v[38:39], v25 offset:33280
    s_add_u32 s92, s99, 11
    s_cmp_ge_u32 s92, 14
    s_cselect_b32 s93, 14, 0
    s_sub_u32 s92, s92, s93
    s_mul_i32 s93, s92, 24576
    s_add_u32 s93, s93, s27
    s_cmp_eq_u32 s92, s30
    s_cselect_b32 s31, 2146435072, s93
    buffer_load_dwordx4 v[112:115], v21, s[12:15], s31 offen offset:0 sc1
    v_mfma_f32_32x32x16_bf16 a[32:47], v[180:183], v[48:51], a[32:47]
    ds_read_b64_tr_b16 v[40:41], v24 offset:34816
    ds_read_b64_tr_b16 v[42:43], v24 offset:35328
    v_mfma_f32_32x32x16_bf16 a[48:63], v[180:183], v[52:55], a[48:63]
    ds_read_b64_tr_b16 v[44:45], v25 offset:34816
    ds_read_b64_tr_b16 v[46:47], v25 offset:35328
    buffer_load_dwordx4 v[116:119], v21, s[12:15], s31 offen offset:1024 sc1
    v_mfma_f32_32x32x16_bf16 a[0:15], v[184:187], v[56:59], a[0:15]
    v_mfma_f32_32x32x16_bf16 a[16:31], v[184:187], v[60:63], a[16:31]
    buffer_load_dwordx4 v[120:123], v21, s[12:15], s31 offen offset:2048 sc1
    v_mfma_f32_32x32x16_bf16 a[32:47], v[188:191], v[56:59], a[32:47]
    v_mfma_f32_32x32x16_bf16 a[48:63], v[188:191], v[60:63], a[48:63]
    buffer_load_dwordx4 v[124:127], v21, s[12:15], s31 offen offset:3072 sc1
    s_waitcnt vmcnt(12)
    s_waitcnt lgkmcnt(0)
    v_mfma_f32_32x32x16_bf16 a[0:15], v[64:67], v[32:35], a[0:15]
    ds_read_b64_tr_b16 v[48:49], v24 offset:36864
    ds_read_b64_tr_b16 v[50:51], v24 offset:37376
    v_mfma_f32_32x32x16_bf16 a[16:31], v[64:67], v[36:39], a[16:31]
    ds_read_b64_tr_b16 v[52:53], v25 offset:36864
    ds_read_b64_tr_b16 v[54:55], v25 offset:37376
    s_add_u32 s92, s99, 12
    s_cmp_ge_u32 s92, 14
    s_cselect_b32 s93, 14, 0
    s_sub_u32 s92, s92, s93
    s_mul_i32 s93, s92, 24576
    s_add_u32 s93, s93, s27
    s_cmp_eq_u32 s92, s30
    s_cselect_b32 s31, 2146435072, s93
    buffer_load_dwordx4 v[128:131], v21, s[12:15], s31 offen offset:0 sc1
    v_mfma_f32_32x32x16_bf16 a[32:47], v[68:71], v[32:35], a[32:47]
    ds_read_b64_tr_b16 v[56:57], v24 offset:38912
    ds_read_b64_tr_b16 v[58:59], v24 offset:39424
    v_mfma_f32_32x32x16_bf16 a[48:63], v[68:71], v[36:39], a[48:63]
    ds_read_b64_tr_b16 v[60:61], v25 offset:38912
    ds_read_b64_tr_b16 v[62:63], v25 offset:39424
    buffer_load_dwordx4 v[132:135], v21, s[12:15], s31 offen offset:1024 sc1
    v_mfma_f32_32x32x16_bf16 a[0:15], v[72:75], v[40:43], a[0:15]
    v_mfma_f32_32x32x16_bf16 a[16:31], v[72:75], v[44:47], a[16:31]
    buffer_load_dwordx4 v[136:139], v21, s[12:15], s31 offen offset:2048 sc1
    v_mfma_f32_32x32x16_bf16 a[32:47], v[76:79], v[40:43], a[32:47]
    v_mfma_f32_32x32x16_bf16 a[48:63], v[76:79], v[44:47], a[48:63]
    buffer_load_dwordx4 v[140:143], v21, s[12:15], s31 offen offset:3072 sc1
    s_waitcnt vmcnt(12)
    s_waitcnt lgkmcnt(0)
    v_mfma_f32_32x32x16_bf16 a[0:15], v[80:83], v[48:51], a[0:15]
    ds_read_b64_tr_b16 v[32:33], v24 offset:0
    ds_read_b64_tr_b16 v[34:35], v24 offset:512
    v_mfma_f32_32x32x16_bf16 a[16:31], v[80:83], v[52:55], a[16:31]
    ds_read_b64_tr_b16 v[36:37], v25 offset:0
    ds_read_b64_tr_b16 v[38:39], v25 offset:512
    s_add_u32 s92, s99, 13
    s_cmp_ge_u32 s92, 14
    s_cselect_b32 s93, 14, 0
    s_sub_u32 s92, s92, s93
    s_mul_i32 s93, s92, 24576
    s_add_u32 s93, s93, s27
    s_cmp_eq_u32 s92, s30
    s_cselect_b32 s31, 2146435072, s93
    buffer_load_dwordx4 v[144:147], v21, s[12:15], s31 offen offset:0 sc1
    v_mfma_f32_32x32x16_bf16 a[32:47], v[84:87], v[48:51], a[32:47]
    ds_read_b64_tr_b16 v[40:41], v24 offset:2048
    ds_read_b64_tr_b16 v[42:43], v24 offset:2560
    v_mfma_f32_32x32x16_bf16 a[48:63], v[84:87], v[52:55], a[48:63]
    ds_read_b64_tr_b16 v[44:45], v25 offset:2048
    ds_read_b64_tr_b16 v[46:47], v25 offset:2560
    buffer_load_dwordx4 v[148:151], v21, s[12:15], s31 offen offset:1024 sc1
    v_mfma_f32_32x32x16_bf16 a[0:15], v[88:91], v[56:59], a[0:15]
    v_mfma_f32_32x32x16_bf16 a[16:31], v[88:91], v[60:63], a[16:31]
    buffer_load_dwordx4 v[152:155], v21, s[12:15], s31 offen offset:2048 sc1
    v_mfma_f32_32x32x16_bf16 a[32:47], v[92:95], v[56:59], a[32:47]
    v_mfma_f32_32x32x16_bf16 a[48:63], v[92:95], v[60:63], a[48:63]
    buffer_load_dwordx4 v[156:159], v21, s[12:15], s31 offen offset:3072 sc1
    s_waitcnt vmcnt(12)
    s_waitcnt lgkmcnt(0)
    v_mfma_f32_32x32x16_bf16 a[0:15], v[96:99], v[32:35], a[0:15]
    ds_read_b64_tr_b16 v[48:49], v24 offset:4096
    ds_read_b64_tr_b16 v[50:51], v24 offset:4608
    v_mfma_f32_32x32x16_bf16 a[16:31], v[96:99], v[36:39], a[16:31]
    ds_read_b64_tr_b16 v[52:53], v25 offset:4096
    ds_read_b64_tr_b16 v[54:55], v25 offset:4608
    s_add_u32 s92, s99, 13
    s_cmp_ge_u32 s92, 14
    s_cselect_b32 s93, 14, 0
    s_sub_u32 s92, s92, s93
    s_mul_i32 s93, s92, 24576
    s_add_u32 s93, s93, s27
    s_cmp_eq_u32 s92, s30
    s_cselect_b32 s31, 2146435072, s93
    buffer_load_dwordx4 v[192:195], v27, s[12:15], s31 offen offset:0 sc1
    v_mfma_f32_32x32x16_bf16 a[32:47], v[100:103], v[32:35], a[32:47]
    ds_read_b64_tr_b16 v[56:57], v24 offset:6144
    ds_read_b64_tr_b16 v[58:59], v24 offset:6656
    v_mfma_f32_32x32x16_bf16 a[48:63], v[100:103], v[36:39], a[48:63]
    ds_read_b64_tr_b16 v[60:61], v25 offset:6144
    ds_read_b64_tr_b16 v[62:63], v25 offset:6656
    buffer_load_dwordx4 v[196:199], v27, s[12:15], s31 offen offset:1024 sc1
    v_mfma_f32_32x32x16_bf16 a[0:15], v[104:107], v[40:43], a[0:15]
    v_mfma_f32_32x32x16_bf16 a[16:31], v[104:107], v[44:47], a[16:31]
    s_add_u32 s92, s99, 12
    s_cmp_ge_u32 s92, 14
    s_cselect_b32 s93, 14, 0
    s_sub_u32 s92, s92, s93
    s_mul_i32 s93, s92, 24576
    s_add_u32 s93, s93, s27
    s_cmp_eq_u32 s92, s30
    s_cselect_b32 s31, 2146435072, s93
    buffer_load_dwordx4 v[200:203], v27, s[12:15], s31 offen offset:0 sc1
    v_mfma_f32_32x32x16_bf16 a[32:47], v[108:111], v[40:43], a[32:47]
    v_mfma_f32_32x32x16_bf16 a[48:63], v[108:111], v[44:47], a[48:63]
    buffer_load_dwordx4 v[204:207], v27, s[12:15], s31 offen offset:1024 sc1
    s_waitcnt vmcnt(12)
    s_waitcnt lgkmcnt(0)
    v_mfma_f32_32x32x16_bf16 a[0:15], v[112:115], v[48:51], a[0:15]
    ds_read_b64_tr_b16 v[32:33], v24 offset:8192
    ds_read_b64_tr_b16 v[34:35], v24 offset:8704
    v_mfma_f32_32x32x16_bf16 a[16:31], v[112:115], v[52:55], a[16:31]
    ds_read_b64_tr_b16 v[36:37], v25 offset:8192
    ds_read_b64_tr_b16 v[38:39], v25 offset:8704
    s_add_u32 s92, s99, 0
    s_cmp_ge_u32 s92, 14
    s_cselect_b32 s93, 14, 0
    s_sub_u32 s92, s92, s93
    s_mul_i32 s93, s92, 24576
    s_add_u32 s93, s93, s27
    s_cmp_eq_u32 s92, s30
    s_cselect_b32 s31, 2146435072, s93
    buffer_load_dwordx4 v[208:211], v27, s[12:15], s31 offen offset:0 sc1
    v_mfma_f32_32x32x16_bf16 a[32:47], v[116:119], v[48:51], a[32:47]
    ds_read_b64_tr_b16 v[40:41], v24 offset:10240
    ds_read_b64_tr_b16 v[42:43], v24 offset:10752
    v_mfma_f32_32x32x16_bf16 a[48:63], v[116:119], v[52:55], a[48:63]
    ds_read_b64_tr_b16 v[44:45], v25 offset:10240
    ds_read_b64_tr_b16 v[46:47], v25 offset:10752
    buffer_load_dwordx4 v[212:215], v27, s[12:15], s31 offen offset:1024 sc1
    v_mfma_f32_32x32x16_bf16 a[0:15], v[120:123], v[56:59], a[0:15]
    v_mfma_f32_32x32x16_bf16 a[16:31], v[120:123], v[60:63], a[16:31]
    s_add_u32 s92, s99, 1
    s_cmp_ge_u32 s92, 14
    s_cselect_b32 s93, 14, 0
    s_sub_u32 s92, s92, s93
    s_mul_i32 s93, s92, 24576
    s_add_u32 s93, s93, s27
    s_cmp_eq_u32 s92, s30
    s_cselect_b32 s31, 2146435072, s93
    buffer_load_dwordx4 v[216:219], v27, s[12:15], s31 offen offset:0 sc1
    v_mfma_f32_32x32x16_bf16 a[32:47], v[124:127], v[56:59], a[32:47]
    v_mfma_f32_32x32x16_bf16 a[48:63], v[124:127], v[60:63], a[48:63]
    buffer_load_dwordx4 v[220:223], v27, s[12:15], s31 offen offset:1024 sc1
    s_waitcnt vmcnt(12)
    s_waitcnt lgkmcnt(0)
    v_mfma_f32_32x32x16_bf16 a[0:15], v[128:131], v[32:35], a[0:15]
    ds_read_b64_tr_b16 v[48:49], v24 offset:12288
    ds_read_b64_tr_b16 v[50:51], v24 offset:12800
    v_mfma_f32_32x32x16_bf16 a[16:31], v[128:131], v[36:39], a[16:31]
    ds_read_b64_tr_b16 v[52:53], v25 offset:12288
    ds_read_b64_tr_b16 v[54:55], v25 offset:12800
    s_add_u32 s92, s99, 2
    s_cmp_ge_u32 s92, 14
    s_cselect_b32 s93, 14, 0
    s_sub_u32 s92, s92, s93
    s_mul_i32 s93, s92, 24576
    s_add_u32 s93, s93, s27
    s_cmp_eq_u32 s92, s30
    s_cselect_b32 s31, 2146435072, s93
    buffer_load_dwordx4 v[224:227], v27, s[12:15], s31 offen offset:0 sc1
    v_mfma_f32_32x32x16_bf16 a[32:47], v[132:135], v[32:35], a[32:47]
    ds_read_b64_tr_b16 v[56:57], v24 offset:14336
    ds_read_b64_tr_b16 v[58:59], v24 offset:14848
    v_mfma_f32_32x32x16_bf16 a[48:63], v[132:135], v[36:39], a[48:63]
    ds_read_b64_tr_b16 v[60:61], v25 offset:14336
    ds_read_b64_tr_b16 v[62:63], v25 offset:14848
    buffer_load_dwordx4 v[228:231], v27, s[12:15], s31 offen offset:1024 sc1
    v_mfma_f32_32x32x16_bf16 a[0:15], v[136:139], v[40:43], a[0:15]
    v_mfma_f32_32x32x16_bf16 a[16:31], v[136:139], v[44:47], a[16:31]
    s_add_u32 s92, s99, 3
    s_cmp_ge_u32 s92, 14
    s_cselect_b32 s93, 14, 0
    s_sub_u32 s92, s92, s93
    s_mul_i32 s93, s92, 24576
    s_add_u32 s93, s93, s27
    s_cmp_eq_u32 s92, s30
    s_cselect_b32 s31, 2146435072, s93
    buffer_load_dwordx4 v[232:235], v27, s[12:15], s31 offen offset:0 sc1
    v_mfma_f32_32x32x16_bf16 a[32:47], v[140:143], v[40:43], a[32:47]
    v_mfma_f32_32x32x16_bf16 a[48:63], v[140:143], v[44:47], a[48:63]
    buffer_load_dwordx4 v[236:239], v27, s[12:15], s31 offen offset:1024 sc1
    s_waitcnt vmcnt(12)
    s_waitcnt lgkmcnt(0)
    v_mfma_f32_32x32x16_bf16 a[0:15], v[144:147], v[48:51], a[0:15]
    v_mfma_f32_32x32x16_bf16 a[16:31], v[144:147], v[52:55], a[16:31]
    s_add_u32 s92, s99, 4
    s_cmp_ge_u32 s92, 14
    s_cselect_b32 s93, 14, 0
    s_sub_u32 s92, s92, s93
    s_mul_i32 s93, s92, 24576
    s_add_u32 s93, s93, s27
    s_cmp_eq_u32 s92, s30
    s_cselect_b32 s31, 2146435072, s93
    buffer_load_dwordx4 v[240:243], v27, s[12:15], s31 offen offset:0 sc1
    v_mfma_f32_32x32x16_bf16 a[32:47], v[148:151], v[48:51], a[32:47]
    v_mfma_f32_32x32x16_bf16 a[48:63], v[148:151], v[52:55], a[48:63]
    buffer_load_dwordx4 v[244:247], v27, s[12:15], s31 offen offset:1024 sc1
    v_mfma_f32_32x32x16_bf16 a[0:15], v[152:155], v[56:59], a[0:15]
    v_mfma_f32_32x32x16_bf16 a[16:31], v[152:155], v[60:63], a[16:31]
    s_add_u32 s92, s99, 5
    s_cmp_ge_u32 s92, 14
    s_cselect_b32 s93, 14, 0
    s_sub_u32 s92, s92, s93
    s_mul_i32 s93, s92, 24576
    s_add_u32 s93, s93, s27
    s_cmp_eq_u32 s92, s30
    s_cselect_b32 s31, 2146435072, s93
    buffer_load_dwordx4 v[248:251], v27, s[12:15], s31 offen offset:0 sc1
    v_mfma_f32_32x32x16_bf16 a[32:47], v[156:159], v[56:59], a[32:47]
    v_mfma_f32_32x32x16_bf16 a[48:63], v[156:159], v[60:63], a[48:63]
    buffer_load_dwordx4 v[252:255], v27, s[12:15], s31 offen offset:1024 sc1
    s_waitcnt vmcnt(14)
    v_mfma_f32_32x32x16_bf16 a[64:79], v[192:195], v[48:51], 0
    s_add_u32 s92, s99, 6
    s_cmp_ge_u32 s92, 14
    s_cselect_b32 s93, 14, 0
    s_sub_u32 s92, s92, s93
    s_mul_i32 s93, s92, 24576
    s_add_u32 s93, s93, s27
    s_cmp_eq_u32 s92, s30
    s_cselect_b32 s31, 2146435072, s93
    buffer_load_dwordx4 a[160:163], v27, s[12:15], s31 offen offset:0 sc1
    v_mfma_f32_32x32x16_bf16 a[80:95], v[192:195], v[52:55], 0
    buffer_load_dwordx4 a[164:167], v27, s[12:15], s31 offen offset:1024 sc1
    v_mfma_f32_32x32x16_bf16 a[64:79], v[196:199], v[56:59], a[64:79]
    s_add_u32 s92, s99, 7
    s_cmp_ge_u32 s92, 14
    s_cselect_b32 s93, 14, 0
    s_sub_u32 s92, s92, s93
    s_mul_i32 s93, s92, 24576
    s_add_u32 s93, s93, s27
    s_cmp_eq_u32 s92, s30
    s_cselect_b32 s31, 2146435072, s93
    buffer_load_dwordx4 a[168:171], v27, s[12:15], s31 offen offset:0 sc1
    s_nop 7
    v_mfma_f32_32x32x16_bf16 a[80:95], v[196:199], v[60:63], a[80:95]
    buffer_load_dwordx4 a[172:175], v27, s[12:15], s31 offen offset:1024 sc1
    ds_write_b128 v23, a[16:19] offset:16384
    ds_write_b128 v23, a[20:23] offset:17408
    s_waitcnt vmcnt(16)
    v_mfma_f32_32x32x16_bf16 a[64:79], v[200:203], v[32:35], a[64:79]
    s_add_u32 s92, s99, 8
    s_cmp_ge_u32 s92, 14
    s_cselect_b32 s93, 14, 0
    s_sub_u32 s92, s92, s93
    s_mul_i32 s93, s92, 24576
    s_add_u32 s93, s93, s27
    s_cmp_eq_u32 s92, s30
    s_cselect_b32 s31, 2146435072, s93
    buffer_load_dwordx4 a[176:179], v27, s[12:15], s31 offen offset:0 sc1
    ds_write_b128 v23, a[8:11] offset:18432
    v_accvgpr_read_b32 v64, a0
    v_accvgpr_read_b32 v65, a1
    v_accvgpr_read_b32 v66, a2
    v_mfma_f32_32x32x16_bf16 a[80:95], v[200:203], v[36:39], a[80:95]
    buffer_load_dwordx4 a[180:183], v27, s[12:15], s31 offen offset:1024 sc1
    ds_write_b128 v23, a[12:15] offset:19456
    ds_write_b128 v23, a[24:27] offset:20480
    v_accvgpr_read_b32 v67, a3
    v_accvgpr_read_b32 v68, a4
    v_mfma_f32_32x32x16_bf16 a[64:79], v[204:207], v[40:43], a[64:79]
    s_add_u32 s92, s99, 9
    s_cmp_ge_u32 s92, 14
    s_cselect_b32 s93, 14, 0
    s_sub_u32 s92, s92, s93
    s_mul_i32 s93, s92, 24576
    s_add_u32 s93, s93, s27
    s_cmp_eq_u32 s92, s30
    s_cselect_b32 s31, 2146435072, s93
    buffer_load_dwordx4 a[184:187], v27, s[12:15], s31 offen offset:0 sc1
    ds_write_b128 v23, a[28:31] offset:21504
    v_accvgpr_read_b32 v69, a5
    v_accvgpr_read_b32 v70, a6
    v_mfma_f32_32x32x16_bf16 a[80:95], v[204:207], v[44:47], a[80:95]
    buffer_load_dwordx4 a[188:191], v27, s[12:15], s31 offen offset:1024 sc1
    ds_write_b128 v23, a[48:51] offset:22528
    ds_write_b128 v23, a[52:55] offset:23552
    v_accvgpr_read_b32 v71, a7
    v_accvgpr_read_b32 v96, a32
    v_accvgpr_read_b32 v97, a33
    s_waitcnt vmcnt(18)
    v_mfma_f32_32x32x16_bf16 a[64:79], v[208:211], a[96:99], a[64:79]
    s_add_u32 s92, s99, 10
    s_cmp_ge_u32 s92, 14
    s_cselect_b32 s93, 14, 0
    s_sub_u32 s92, s92, s93
    s_mul_i32 s93, s92, 24576
    s_add_u32 s93, s93, s27
    s_cmp_eq_u32 s92, s30
    s_cselect_b32 s31, 2146435072, s93
    buffer_load_dwordx4 a[240:243], v27, s[12:15], s31 offen offset:0 sc1
    ds_write_b128 v23, a[40:43] offset:24576
    v_accvgpr_read_b32 v98, a34
    v_accvgpr_read_b32 v99, a35
    v_mfma_f32_32x32x16_bf16 a[80:95], v[208:211], a[100:103], a[80:95]
    buffer_load_dwordx4 a[244:247], v27, s[12:15], s31 offen offset:1024 sc1
    ds_write_b128 v23, a[44:47] offset:25600
    ds_write_b128 v23, a[56:59] offset:26624
    v_accvgpr_read_b32 v100, a36
    v_accvgpr_read_b32 v101, a37
    v_mfma_f32_32x32x16_bf16 a[64:79], v[212:215], a[104:107], a[64:79]
    s_add_u32 s92, s99, 11
    s_cmp_ge_u32 s92, 14
    s_cselect_b32 s93, 14, 0
    s_sub_u32 s92, s92, s93
    s_mul_i32 s93, s92, 24576
    s_add_u32 s93, s93, s27
    s_cmp_eq_u32 s92, s30
    s_cselect_b32 s31, 2146435072, s93
    buffer_load_dwordx4 a[248:251], v27, s[12:15], s31 offen offset:0 sc1
    ds_write_b128 v23, a[60:63] offset:27648
    v_accvgpr_read_b32 v102, a38
    v_accvgpr_read_b32 v103, a39
    v_mfma_f32_32x32x16_bf16 a[80:95], v[212:215], a[108:111], a[80:95]
    buffer_load_dwordx4 a[252:255], v27, s[12:15], s31 offen offset:1024 sc1
    s_waitcnt vmcnt(20)
    s_waitcnt lgkmcnt(0)
    s_barrier
    v_mfma_f32_32x32x16_bf16 a[64:79], v[216:219], a[112:115], a[64:79]
    ds_read_b128 v[72:75], v4 offset:16384
    ds_read_b128 v[76:79], v4 offset:17408
    ds_read_b128 v[80:83], v5 offset:18432
    ds_read_b128 v[84:87], v5 offset:19456
    v_mfma_f32_32x32x16_bf16 a[80:95], v[216:219], a[116:119], a[80:95]
    ds_read_b128 v[88:91], v6 offset:20480
    ds_read_b128 v[92:95], v6 offset:21504
    ds_read_b128 v[104:107], v4 offset:22528
    ds_read_b128 v[108:111], v4 offset:23552
    v_mfma_f32_32x32x16_bf16 a[64:79], v[220:223], a[120:123], a[64:79]
    ds_read_b128 v[112:115], v5 offset:24576
    ds_read_b128 v[116:119], v5 offset:25600
    ds_read_b128 v[120:123], v6 offset:26624
    ds_read_b128 v[124:127], v6 offset:27648
    v_mfma_f32_32x32x16_bf16 a[80:95], v[220:223], a[124:127], a[80:95]
    s_waitcnt vmcnt(18)
    s_waitcnt lgkmcnt(0)
    v_mfma_f32_32x32x16_bf16 a[64:79], v[224:227], a[128:131], a[64:79]
    v_pk_add_f32 v[64:65], v[64:65], v[72:73]
    v_pk_add_f32 v[80:81], v[80:81], v[88:89]
    v_pk_add_f32 v[66:67], v[66:67], v[74:75]
    v_pk_add_f32 v[82:83], v[82:83], v[90:91]
    v_pk_add_f32 v[68:69], v[68:69], v[76:77]
    v_pk_add_f32 v[84:85], v[84:85], v[92:93]
    v_mfma_f32_32x32x16_bf16 a[80:95], v[224:227], a[132:135], a[80:95]
    v_pk_add_f32 v[70:71], v[70:71], v[78:79]
    v_pk_add_f32 v[86:87], v[86:87], v[94:95]
    v_pk_add_f32 v[64:65], v[64:65], v[80:81]
    v_pk_add_f32 v[66:67], v[66:67], v[82:83]
    v_pk_add_f32 v[68:69], v[68:69], v[84:85]
    v_pk_add_f32 v[70:71], v[70:71], v[86:87]
    v_mfma_f32_32x32x16_bf16 a[64:79], v[228:231], a[136:139], a[64:79]
    v_cvt_pk_bf16_f32 v8, v64, v65
    v_cvt_pk_bf16_f32 v9, v66, v67
    v_cvt_pk_bf16_f32 v10, v68, v69
    v_cvt_pk_bf16_f32 v11, v70, v71
    s_nop 1
    v_permlane32_swap_b32 v8, v10
    v_permlane32_swap_b32 v9, v11
    buffer_store_dwordx4 v[8:11], v20, s[16:19], s40 offen offset:0 sc1
    v_mfma_f32_32x32x16_bf16 a[80:95], v[228:231], a[140:143], a[80:95]
    v_pk_add_f32 v[96:97], v[96:97], v[104:105]
    v_pk_add_f32 v[112:113], v[112:113], v[120:121]
    v_pk_add_f32 v[98:99], v[98:99], v[106:107]
    v_pk_add_f32 v[114:115], v[114:115], v[122:123]
    v_pk_add_f32 v[100:101], v[100:101], v[108:109]
    v_pk_add_f32 v[116:117], v[116:117], v[124:125]
    s_waitcnt vmcnt(17)
    v_mfma_f32_32x32x16_bf16 a[64:79], v[232:235], a[144:147], a[64:79]
    v_pk_add_f32 v[102:103], v[102:103], v[110:111]
    v_pk_add_f32 v[118:119], v[118:119], v[126:127]
    v_pk_add_f32 v[96:97], v[96:97], v[112:113]
    v_pk_add_f32 v[98:99], v[98:99], v[114:115]
    v_pk_add_f32 v[100:101], v[100:101], v[116:117]
    v_pk_add_f32 v[102:103], v[102:103], v[118:119]
    v_mfma_f32_32x32x16_bf16 a[80:95], v[232:235], a[148:151], a[80:95]
    v_cvt_pk_bf16_f32 v12, v96, v97
    v_cvt_pk_bf16_f32 v13, v98, v99
    v_cvt_pk_bf16_f32 v14, v100, v101
    v_cvt_pk_bf16_f32 v15, v102, v103
    s_nop 1
    v_permlane32_swap_b32 v12, v14
    v_permlane32_swap_b32 v13, v15
    buffer_store_dwordx4 v[12:15], v20, s[16:19], s40 offen offset:2048 sc1
    v_mfma_f32_32x32x16_bf16 a[64:79], v[236:239], a[152:155], a[64:79]
    v_mfma_f32_32x32x16_bf16 a[80:95], v[236:239], a[156:159], a[80:95]
    s_waitcnt vmcnt(16)
    v_mfma_f32_32x32x16_bf16 a[64:79], v[240:243], a[192:195], a[64:79]
    v_mfma_f32_32x32x16_bf16 a[80:95], v[240:243], a[196:199], a[80:95]
    v_mfma_f32_32x32x16_bf16 a[64:79], v[244:247], a[200:203], a[64:79]
    ds_read_b64_tr_b16 v[48:49], v24 offset:28672
    ds_read_b64_tr_b16 v[50:51], v24 offset:29184
    ds_read_b64_tr_b16 v[52:53], v25 offset:28672
    v_mfma_f32_32x32x16_bf16 a[80:95], v[244:247], a[204:207], a[80:95]
    ds_read_b64_tr_b16 v[54:55], v25 offset:29184
    ds_read_b64_tr_b16 v[56:57], v24 offset:30720
    ds_read_b64_tr_b16 v[58:59], v24 offset:31232
    s_waitcnt vmcnt(14)
    v_mfma_f32_32x32x16_bf16 a[64:79], v[248:251], a[208:211], a[64:79]
    ds_read_b64_tr_b16 v[60:61], v25 offset:30720
    ds_read_b64_tr_b16 v[62:63], v25 offset:31232
    v_mfma_f32_32x32x16_bf16 a[80:95], v[248:251], a[212:215], a[80:95]
    ds_read_b64_tr_b16 v[32:33], v24 offset:32768
    ds_read_b64_tr_b16 v[34:35], v24 offset:33280
    ds_read_b64_tr_b16 v[36:37], v25 offset:32768
    v_mfma_f32_32x32x16_bf16 a[64:79], v[252:255], a[216:219], a[64:79]
    ds_read_b64_tr_b16 v[38:39], v25 offset:33280
    ds_read_b64_tr_b16 v[40:41], v24 offset:34816
    ds_read_b64_tr_b16 v[42:43], v24 offset:35328
    v_mfma_f32_32x32x16_bf16 a[80:95], v[252:255], a[220:223], a[80:95]
    ds_read_b64_tr_b16 v[44:45], v25 offset:34816
    ds_read_b64_tr_b16 v[46:47], v25 offset:35328
    s_waitcnt vmcnt(12)
    v_mfma_f32_32x32x16_bf16 a[64:79], a[160:163], a[224:227], a[64:79]
    v_mfma_f32_32x32x16_bf16 a[80:95], a[160:163], a[228:231], a[80:95]
    v_mfma_f32_32x32x16_bf16 a[64:79], a[164:167], a[232:235], a[64:79]
    v_mfma_f32_32x32x16_bf16 a[80:95], a[164:167], a[236:239], a[80:95]
    ds_read_b64_tr_b16 v[64:65], v24 offset:36864
    ds_read_b64_tr_b16 v[66:67], v24 offset:37376
    ds_read_b64_tr_b16 v[68:69], v25 offset:36864
    s_waitcnt vmcnt(10)
    s_waitcnt lgkmcnt(3)
    v_mfma_f32_32x32x16_bf16 a[64:79], a[168:171], v[48:51], a[64:79]
    ds_read_b64_tr_b16 v[70:71], v25 offset:37376
    ds_read_b64_tr_b16 v[72:73], v24 offset:38912
    ds_read_b64_tr_b16 v[74:75], v24 offset:39424
    v_mfma_f32_32x32x16_bf16 a[80:95], a[168:171], v[52:55], a[80:95]
    ds_read_b64_tr_b16 v[76:77], v25 offset:38912
    ds_read_b64_tr_b16 v[78:79], v25 offset:39424
    v_mfma_f32_32x32x16_bf16 a[64:79], a[172:175], v[56:59], a[64:79]
    ds_read_b64_tr_b16 v[80:81], v24 offset:0
    ds_read_b64_tr_b16 v[82:83], v24 offset:512
    ds_read_b64_tr_b16 v[84:85], v25 offset:0
    v_mfma_f32_32x32x16_bf16 a[80:95], a[172:175], v[60:63], a[80:95]
    ds_read_b64_tr_b16 v[86:87], v25 offset:512
    ds_read_b64_tr_b16 v[88:89], v24 offset:2048
    ds_read_b64_tr_b16 v[90:91], v24 offset:2560
    s_waitcnt vmcnt(8)
    s_waitcnt vmcnt(0)
    s_barrier
    s_cmp_lg_u32 s3, 0
    s_cbranch_scc1 standalone__weight_only_int_quip__prompt_kernel_pub6
    v_mov_b32 v30, s38
    v_mov_b32 v31, s39
    s_mov_b64 exec, 0xffff
    buffer_store_dwordx2 v[30:31], v28, s[32:35], 0 offen offset:0 sc1
    s_mov_b64 exec, -1
standalone__weight_only_int_quip__prompt_kernel_pub6:

    buffer_load_dwordx2 v[14:15], v29, s[32:35], 0 offen sc1
    v_mfma_f32_32x32x16_bf16 a[64:79], a[176:179], v[32:35], a[64:79]
    ds_read_b64_tr_b16 v[92:93], v25 offset:2048
    ds_read_b64_tr_b16 v[94:95], v25 offset:2560
    v_mfma_f32_32x32x16_bf16 a[80:95], a[176:179], v[36:39], a[80:95]
    ds_read_b64_tr_b16 v[96:97], v24 offset:4096
    ds_read_b64_tr_b16 v[98:99], v24 offset:4608
    ds_read_b64_tr_b16 v[100:101], v25 offset:4096
    v_mfma_f32_32x32x16_bf16 a[64:79], a[180:183], v[40:43], a[64:79]
    ds_read_b64_tr_b16 v[102:103], v25 offset:4608
    ds_read_b64_tr_b16 v[104:105], v24 offset:6144
    ds_read_b64_tr_b16 v[106:107], v24 offset:6656
    v_mfma_f32_32x32x16_bf16 a[80:95], a[180:183], v[44:47], a[80:95]
    ds_read_b64_tr_b16 v[108:109], v25 offset:6144
    ds_read_b64_tr_b16 v[110:111], v25 offset:6656
    s_waitcnt lgkmcnt(8)
    v_mfma_f32_32x32x16_bf16 a[64:79], a[184:187], v[64:67], a[64:79]
    v_mfma_f32_32x32x16_bf16 a[80:95], a[184:187], v[68:71], a[80:95]
    v_mfma_f32_32x32x16_bf16 a[64:79], a[188:191], v[72:75], a[64:79]
    v_mfma_f32_32x32x16_bf16 a[80:95], a[188:191], v[76:79], a[80:95]
    v_mfma_f32_32x32x16_bf16 a[64:79], a[240:243], v[80:83], a[64:79]
    v_mfma_f32_32x32x16_bf16 a[80:95], a[240:243], v[84:87], a[80:95]
    v_mfma_f32_32x32x16_bf16 a[64:79], a[244:247], v[88:91], a[64:79]
    v_mfma_f32_32x32x16_bf16 a[80:95], a[244:247], v[92:95], a[80:95]
    s_waitcnt lgkmcnt(0)
    v_mfma_f32_32x32x16_bf16 a[64:79], a[248:251], v[96:99], a[64:79]
    v_mfma_f32_32x32x16_bf16 a[80:95], a[248:251], v[100:103], a[80:95]
    v_mfma_f32_32x32x16_bf16 a[64:79], a[252:255], v[104:107], a[64:79]
    v_mfma_f32_32x32x16_bf16 a[80:95], a[252:255], v[108:111], a[80:95]
    s_nop 7
    s_nop 3
    ds_write_b128 v23, a[80:83] offset:0
    ds_write_b128 v23, a[84:87] offset:1024
    ds_write_b128 v23, a[72:75] offset:2048
    ds_write_b128 v23, a[76:79] offset:3072
    ds_write_b128 v23, a[88:91] offset:4096
    ds_write_b128 v23, a[92:95] offset:5120
    v_accvgpr_read_b32 v32, a64
    v_accvgpr_read_b32 v33, a65
    v_accvgpr_read_b32 v34, a66
    v_accvgpr_read_b32 v35, a67
    v_accvgpr_read_b32 v36, a68
    v_accvgpr_read_b32 v37, a69
    v_accvgpr_read_b32 v38, a70
    v_accvgpr_read_b32 v39, a71
    s_waitcnt vmcnt(0)
    v_cmp_ne_u64 vcc, s[38:39], v[14:15]
    s_waitcnt lgkmcnt(0)
    s_barrier
    s_cmp_eq_u64 vcc, 0
    s_cselect_b32 s36, 1, 0
    ds_read_b128 v[40:43], v4 offset:0
    ds_read_b128 v[44:47], v4 offset:1024
    ds_read_b128 v[48:51], v5 offset:2048
    ds_read_b128 v[52:55], v5 offset:3072
    ds_read_b128 v[56:59], v6 offset:4096
    ds_read_b128 v[60:63], v6 offset:5120
    s_waitcnt lgkmcnt(0)
    v_pk_add_f32 v[32:33], v[32:33], v[40:41]
    v_pk_add_f32 v[48:49], v[48:49], v[56:57]
    v_pk_add_f32 v[34:35], v[34:35], v[42:43]
    v_pk_add_f32 v[50:51], v[50:51], v[58:59]
    v_pk_add_f32 v[36:37], v[36:37], v[44:45]
    v_pk_add_f32 v[52:53], v[52:53], v[60:61]
    v_pk_add_f32 v[38:39], v[38:39], v[46:47]
    v_pk_add_f32 v[54:55], v[54:55], v[62:63]
    v_pk_add_f32 v[32:33], v[32:33], v[48:49]
    v_pk_add_f32 v[34:35], v[34:35], v[50:51]
    v_pk_add_f32 v[36:37], v[36:37], v[52:53]
    v_pk_add_f32 v[38:39], v[38:39], v[54:55]
    v_cvt_pk_bf16_f32 v12, v32, v33
    v_cvt_pk_bf16_f32 v13, v34, v35
    v_cvt_pk_bf16_f32 v14, v36, v37
    v_cvt_pk_bf16_f32 v15, v38, v39
    s_nop 1
    v_permlane32_swap_b32 v12, v14
    v_permlane32_swap_b32 v13, v15
    buffer_store_dwordx4 v[12:15], v20, s[16:19], s41 offen offset:0 sc1
    s_cmp_eq_u32 s36, 0
    s_cbranch_scc1 standalone__weight_only_int_quip__prompt_kernel_late8
    s_lshl_b32 s92, s62, 4
    s_add_u32 s92, s92, s63
    s_lshl_b32 s92, s92, 8
    s_add_u32 s92, s92, 0
    s_cmp_eq_u32 s62, 13
    s_cselect_b32 s93, 14, 15
    v_min_u32 v29, 13, v2
    v_and_b32 v29, s93, v29
    v_lshl_add_u32 v29, v29, 3, s92
    s_add_u32 s92, s92, 128
    v_min_u32 v19, 11, v2
    v_and_b32 v19, s93, v19
    v_lshl_add_u32 v19, v19, 3, s92

    buffer_load_dwordx2 v[30:31], v29, s[32:35], 0 offen sc1
    buffer_load_dwordx4 v[128:131], v20, s[8:11], s25 offen offset:0 sc1
    buffer_load_dwordx4 v[132:135], v20, s[8:11], s25 offen offset:1024 sc1
    buffer_load_dwordx4 v[136:139], v20, s[8:11], s25 offen offset:2048 sc1
    buffer_load_dwordx4 v[140:143], v20, s[8:11], s25 offen offset:3072 sc1
    s_add_u32 s25, s25, 4096
    buffer_load_dwordx4 v[144:147], v20, s[8:11], s25 offen offset:0 sc1
    buffer_load_dwordx4 v[148:151], v20, s[8:11], s25 offen offset:1024 sc1
    buffer_load_dwordx4 v[152:155], v20, s[8:11], s25 offen offset:2048 sc1
    buffer_load_dwordx4 v[156:159], v20, s[8:11], s25 offen offset:3072 sc1
    s_add_u32 s25, s25, 4096
    buffer_load_dwordx4 v[160:163], v20, s[8:11], s25 offen offset:0 sc1
    buffer_load_dwordx4 v[164:167], v20, s[8:11], s25 offen offset:1024 sc1
    buffer_load_dwordx4 v[168:171], v20, s[8:11], s25 offen offset:2048 sc1
    buffer_load_dwordx4 v[172:175], v20, s[8:11], s25 offen offset:3072 sc1
    s_add_u32 s25, s25, 4096
    buffer_load_dwordx4 v[176:179], v20, s[8:11], s25 offen offset:0 sc1
    buffer_load_dwordx4 v[180:183], v20, s[8:11], s25 offen offset:1024 sc1
    buffer_load_dwordx4 v[184:187], v20, s[8:11], s25 offen offset:2048 sc1
    buffer_load_dwordx4 v[188:191], v20, s[8:11], s25 offen offset:3072 sc1
    s_add_u32 s25, s25, 4096
    s_waitcnt vmcnt(16)
    v_cmp_ne_u64 vcc, s[38:39], v[30:31]
    s_cbranch_vccz standalone__weight_only_int_quip__prompt_kernel_join9
    s_branch standalone__weight_only_int_quip__prompt_kernel_ok110
standalone__weight_only_int_quip__prompt_kernel_late8:
    v_mov_b32 v26, v29
    s_lshl_b32 s92, s62, 4
    s_add_u32 s92, s92, s63
    s_lshl_b32 s92, s92, 8
    s_add_u32 s92, s92, 0
    s_cmp_eq_u32 s62, 13
    s_cselect_b32 s93, 14, 15
    v_min_u32 v29, 13, v2
    v_and_b32 v29, s93, v29
    v_lshl_add_u32 v29, v29, 3, s92
    s_add_u32 s92, s92, 128
    v_min_u32 v19, 11, v2
    v_and_b32 v19, s93, v19
    v_lshl_add_u32 v19, v19, 3, s92

    v_cmp_gt_u32 vcc, 32, v2
    s_nop 1
    v_cndmask_b32 v29, v26, v29, vcc
    s_mov_b32 s37, 0
standalone__weight_only_int_quip__prompt_kernel_pl12:
    buffer_load_dwordx2 v[8:9], v29, s[32:35], 0 offen sc1
    s_waitcnt vmcnt(0)
    v_cmp_ne_u64 vcc, s[38:39], v[8:9]
    s_cbranch_vccz standalone__weight_only_int_quip__prompt_kernel_wd11
    s_sleep 1

    s_add_u32 s37, s37, 1
    s_cmp_lt_u32 s37, 524288
    s_cbranch_scc1 standalone__weight_only_int_quip__prompt_kernel_pl12

standalone__weight_only_int_quip__prompt_kernel_wd11:
    buffer_load_dwordx4 v[128:131], v20, s[8:11], s25 offen offset:0 sc1
    buffer_load_dwordx4 v[132:135], v20, s[8:11], s25 offen offset:1024 sc1
    buffer_load_dwordx4 v[136:139], v20, s[8:11], s25 offen offset:2048 sc1
    buffer_load_dwordx4 v[140:143], v20, s[8:11], s25 offen offset:3072 sc1
    s_add_u32 s25, s25, 4096
    buffer_load_dwordx4 v[144:147], v20, s[8:11], s25 offen offset:0 sc1
    buffer_load_dwordx4 v[148:151], v20, s[8:11], s25 offen offset:1024 sc1
    buffer_load_dwordx4 v[152:155], v20, s[8:11], s25 offen offset:2048 sc1
    buffer_load_dwordx4 v[156:159], v20, s[8:11], s25 offen offset:3072 sc1
    s_add_u32 s25, s25, 4096
    buffer_load_dwordx4 v[160:163], v20, s[8:11], s25 offen offset:0 sc1
    buffer_load_dwordx4 v[164:167], v20, s[8:11], s25 offen offset:1024 sc1
    buffer_load_dwordx4 v[168:171], v20, s[8:11], s25 offen offset:2048 sc1
    buffer_load_dwordx4 v[172:175], v20, s[8:11], s25 offen offset:3072 sc1
    s_add_u32 s25, s25, 4096
    buffer_load_dwordx4 v[176:179], v20, s[8:11], s25 offen offset:0 sc1
    buffer_load_dwordx4 v[180:183], v20, s[8:11], s25 offen offset:1024 sc1
    buffer_load_dwordx4 v[184:187], v20, s[8:11], s25 offen offset:2048 sc1
    buffer_load_dwordx4 v[188:191], v20, s[8:11], s25 offen offset:3072 sc1
    s_add_u32 s25, s25, 4096
    s_branch standalone__weight_only_int_quip__prompt_kernel_join9
standalone__weight_only_int_quip__prompt_kernel_ok110:
    s_mov_b32 s37, 0
standalone__weight_only_int_quip__prompt_kernel_pl14:
    buffer_load_dwordx2 v[8:9], v29, s[32:35], 0 offen sc1
    s_waitcnt vmcnt(0)
    v_cmp_ne_u64 vcc, s[38:39], v[8:9]
    s_cbranch_vccz standalone__weight_only_int_quip__prompt_kernel_wd13
    s_sleep 1

    s_add_u32 s37, s37, 1
    s_cmp_lt_u32 s37, 524288
    s_cbranch_scc1 standalone__weight_only_int_quip__prompt_kernel_pl14

standalone__weight_only_int_quip__prompt_kernel_wd13:
standalone__weight_only_int_quip__prompt_kernel_join9:
    s_barrier
    s_cmp_lg_u32 s3, 0
    s_cbranch_scc1 standalone__weight_only_int_quip__prompt_kernel_pub15
    v_mov_b32 v30, s38
    v_mov_b32 v31, s39
    s_mov_b64 exec, 0xffff
    buffer_store_dwordx2 v[30:31], v28, s[32:35], 0 offen offset:128 sc1
    s_mov_b64 exec, -1
standalone__weight_only_int_quip__prompt_kernel_pub15:

    s_branch L_y
L_xrole:
    s_cmp_ge_u32 s36, 64
    s_cbranch_scc1 L_keeper
    s_waitcnt lgkmcnt(0)
    s_add_u32 s32, s60, 7159808
    s_addc_u32 s33, s61, 0
    s_mov_b32 s34, 150784
    s_mov_b32 s35, 0x20000
    s_load_dword s39, s[32:33], 99328
    s_mov_b32 s8, s44
    s_mov_b32 s9, s45
    s_mov_b32 s10, 2621440
    s_mov_b32 s11, 0x20000
    s_mov_b32 s12, s52
    s_mov_b32 s13, s53
    s_mov_b32 s14, 819200
    s_mov_b32 s15, 0x20000
    s_add_u32 s16, s60, 4538368
    s_addc_u32 s17, s61, 0
    s_mov_b32 s18, 2621440
    s_mov_b32 s19, 0x20000
    s_lshr_b32 s6, s36, 2
    s_and_b32 s7, s36, 3
    v_lshrrev_b32 v3, 3, v2
    v_and_b32 v4, 7, v2
    s_lshl_b32 s24, s6, 2
    s_add_u32 s24, s24, s3
    s_mul_i32 s24, s24, 40960

    v_add_u32 v5, 0, v3
    v_bfe_u32 v6, v5, 1, 3
    v_xor_b32 v6, v6, v4
    v_lshlrev_b32 v6, 4, v6
    v_mul_u32_u24 v5, 1280, v5
    v_add_u32 v16, v5, v6

    v_add_u32 v5, 8, v3
    v_bfe_u32 v6, v5, 1, 3
    v_xor_b32 v6, v6, v4
    v_lshlrev_b32 v6, 4, v6
    v_mul_u32_u24 v5, 1280, v5
    v_add_u32 v17, v5, v6

    v_subrev_u32 v17, 1024, v17
    v_add_u32 v5, 16, v3
    v_bfe_u32 v6, v5, 1, 3
    v_xor_b32 v6, v6, v4
    v_lshlrev_b32 v6, 4, v6
    v_mul_u32_u24 v5, 1280, v5
    v_add_u32 v18, v5, v6

    v_subrev_u32 v18, 2048, v18
    v_add_u32 v5, 24, v3
    v_bfe_u32 v6, v5, 1, 3
    v_xor_b32 v6, v6, v4
    v_lshlrev_b32 v6, 4, v6
    v_mul_u32_u24 v5, 1280, v5
    v_add_u32 v19, v5, v6

    v_subrev_u32 v19, 3072, v19
    v_add_u32 v5, 0, v2
    v_mul_u32_u24 v6, 3277, v5
    v_lshrrev_b32 v6, 16, v6
    v_mul_u32_u24 v7, 20, v6
    v_sub_u32 v5, v5, v7
    v_lshlrev_b32 v5, 4, v5
    v_mul_u32_u24 v6, 1280, v6
    v_add_u32 v20, v5, v6

    v_add_u32 v5, 64, v2
    v_mul_u32_u24 v6, 3277, v5
    v_lshrrev_b32 v6, 16, v6
    v_mul_u32_u24 v7, 20, v6
    v_sub_u32 v5, v5, v7
    v_lshlrev_b32 v5, 4, v5
    v_mul_u32_u24 v6, 1280, v6
    v_add_u32 v21, v5, v6

    v_subrev_u32 v21, 1024, v21
    v_add_u32 v5, 128, v2
    v_mul_u32_u24 v6, 3277, v5
    v_lshrrev_b32 v6, 16, v6
    v_mul_u32_u24 v7, 20, v6
    v_sub_u32 v5, v5, v7
    v_lshlrev_b32 v5, 4, v5
    v_mul_u32_u24 v6, 1280, v6
    v_add_u32 v22, v5, v6

    v_subrev_u32 v22, 2048, v22
    v_add_u32 v5, 192, v2
    v_mul_u32_u24 v6, 3277, v5
    v_lshrrev_b32 v6, 16, v6
    v_mul_u32_u24 v7, 20, v6
    v_sub_u32 v5, v5, v7
    v_lshlrev_b32 v5, 4, v5
    v_mul_u32_u24 v6, 1280, v6
    v_add_u32 v23, v5, v6

    v_subrev_u32 v23, 3072, v23
    v_add_u32 v5, 256, v2
    v_mul_u32_u24 v6, 3277, v5
    v_lshrrev_b32 v6, 16, v6
    v_mul_u32_u24 v7, 20, v6
    v_sub_u32 v5, v5, v7
    v_lshlrev_b32 v5, 4, v5
    v_mul_u32_u24 v6, 1280, v6
    v_add_u32 v24, v5, v6

    s_mul_i32 s25, s3, 20480
    s_mul_i32 s26, s7, 320
    s_add_u32 s25, s25, s26
    s_mul_i32 s26, s3, 16384
    s_mul_i32 s27, s3, 5120
    s_add_u32 s27, s27, 65536

    s_mul_i32 s28, s7, 5
    s_lshr_b32 s28, s28, 1
    s_and_b32 s92, s6, 7
    s_add_u32 s28, s28, s92
    s_cmp_ge_u32 s28, 10
    s_cselect_b32 s92, 10, 0
    s_sub_u32 s28, s28, s92
    s_mov_b32 s29, s28
    s_lshl_b32 s30, s28, 7
    s_add_u32 s24, s24, s30
    s_mul_i32 s30, s28, 81920
    s_add_u32 s25, s25, s30

    s_waitcnt lgkmcnt(0)
    s_mul_i32 s38, s39, 0x9E3779B1
    s_add_u32 s38, s38, 0x7F4A7C15
    s_xor_b32 s39, s38, 0x5BD1E995

    s_add_u32 m0, s26, 0
    s_nop 0
    buffer_load_dwordx4 v16, s[8:11], s24 offen offset:0 lds
    buffer_load_dwordx4 v17, s[8:11], s24 offen offset:1024 lds
    buffer_load_dwordx4 v18, s[8:11], s24 offen offset:2048 lds
    buffer_load_dwordx4 v19, s[8:11], s24 offen offset:3072 lds
    s_add_u32 s24, s24, 128
    s_add_u32 s28, s28, 1
    s_cmp_eq_u32 s28, 10
    s_cselect_b32 s93, 1280, 0
    s_sub_u32 s24, s24, s93
    s_add_u32 m0, s27, 0
    s_nop 0
    buffer_load_dwordx4 v20, s[12:15], s25 offen offset:0 lds
    buffer_load_dwordx4 v21, s[12:15], s25 offen offset:1024 lds
    buffer_load_dwordx4 v22, s[12:15], s25 offen offset:2048 lds
    buffer_load_dwordx4 v23, s[12:15], s25 offen offset:3072 lds
    s_add_u32 m0, s27, 4096
    s_nop 0
    buffer_load_dwordx4 v24, s[12:15], s25 offen offset:0 lds
    s_add_u32 s25, s25, 81920
    s_add_u32 s29, s29, 1
    s_cmp_eq_u32 s29, 10
    s_cselect_b32 s93, 819200, 0
    s_sub_u32 s25, s25, s93
    s_add_u32 m0, s26, 4096
    s_nop 0
    buffer_load_dwordx4 v16, s[8:11], s24 offen offset:0 lds
    buffer_load_dwordx4 v17, s[8:11], s24 offen offset:1024 lds
    buffer_load_dwordx4 v18, s[8:11], s24 offen offset:2048 lds
    buffer_load_dwordx4 v19, s[8:11], s24 offen offset:3072 lds
    s_add_u32 s24, s24, 128
    s_add_u32 s28, s28, 1
    s_cmp_eq_u32 s28, 10
    s_cselect_b32 s93, 1280, 0
    s_sub_u32 s24, s24, s93
    s_add_u32 m0, s27, 20480
    s_nop 0
    buffer_load_dwordx4 v20, s[12:15], s25 offen offset:0 lds
    buffer_load_dwordx4 v21, s[12:15], s25 offen offset:1024 lds
    buffer_load_dwordx4 v22, s[12:15], s25 offen offset:2048 lds
    buffer_load_dwordx4 v23, s[12:15], s25 offen offset:3072 lds
    s_add_u32 m0, s27, 24576
    s_nop 0
    buffer_load_dwordx4 v24, s[12:15], s25 offen offset:0 lds
    s_add_u32 s25, s25, 81920
    s_add_u32 s29, s29, 1
    s_cmp_eq_u32 s29, 10
    s_cselect_b32 s93, 819200, 0
    s_sub_u32 s25, s25, s93
    v_and_b32 v3, 31, v2
    v_lshrrev_b32 v4, 5, v2
    v_bfe_u32 v5, v3, 1, 3
    v_lshlrev_b32 v6, 7, v3
    v_add_u32 v6, s26, v6

    v_or_b32 v7, 0, v4
    v_xor_b32 v7, v7, v5
    v_lshl_add_u32 v32, v7, 4, v6
    v_or_b32 v7, 2, v4
    v_xor_b32 v7, v7, v5
    v_lshl_add_u32 v33, v7, 4, v6
    v_or_b32 v7, 4, v4
    v_xor_b32 v7, v7, v5
    v_lshl_add_u32 v34, v7, 4, v6
    v_or_b32 v7, 6, v4
    v_xor_b32 v7, v7, v5
    v_lshl_add_u32 v35, v7, 4, v6
    v_bfe_u32 v3, v2, 2, 2
    v_lshl_add_u32 v3, v4, 3, v3
    v_mul_u32_u24 v5, 320, v3
    v_bfe_u32 v6, v2, 4, 1
    v_lshl_add_u32 v5, v6, 5, v5
    v_and_b32 v6, 3, v2
    v_lshl_add_u32 v5, v6, 3, v5
    v_add_u32 v36, 65536, v5
    v_add_u32 v37, 106496, v5

    s_mul_i32 s92, s7, 5
    s_add_u32 s92, s92, 0
    s_mul_i32 s93, s92, 43
    s_lshr_b32 s93, s93, 7
    s_mul_i32 s98, s93, 3
    s_sub_u32 s92, s92, s98
    s_lshl_b32 s98, s93, 1
    s_add_u32 s99, s98, 28
    s_add_u32 s98, s98, s92
    s_lshl_b32 s98, s98, 1
    s_cmp_lt_u32 s92, 2
    s_cselect_b32 s40, s98, s99

    s_mul_i32 s92, s7, 5
    s_add_u32 s92, s92, 1
    s_mul_i32 s93, s92, 43
    s_lshr_b32 s93, s93, 7
    s_mul_i32 s98, s93, 3
    s_sub_u32 s92, s92, s98
    s_lshl_b32 s98, s93, 1
    s_add_u32 s99, s98, 28
    s_add_u32 s98, s98, s92
    s_lshl_b32 s98, s98, 1
    s_cmp_lt_u32 s92, 2
    s_cselect_b32 s41, s98, s99

    s_mul_i32 s92, s7, 5
    s_add_u32 s92, s92, 2
    s_mul_i32 s93, s92, 43
    s_lshr_b32 s93, s93, 7
    s_mul_i32 s98, s93, 3
    s_sub_u32 s92, s92, s98
    s_lshl_b32 s98, s93, 1
    s_add_u32 s99, s98, 28
    s_add_u32 s98, s98, s92
    s_lshl_b32 s98, s98, 1
    s_cmp_lt_u32 s92, 2
    s_cselect_b32 s42, s98, s99

    s_mul_i32 s92, s7, 5
    s_add_u32 s92, s92, 3
    s_mul_i32 s93, s92, 43
    s_lshr_b32 s93, s93, 7
    s_mul_i32 s98, s93, 3
    s_sub_u32 s92, s92, s98
    s_lshl_b32 s98, s93, 1
    s_add_u32 s99, s98, 28
    s_add_u32 s98, s98, s92
    s_lshl_b32 s98, s98, 1
    s_cmp_lt_u32 s92, 2
    s_cselect_b32 s95, s98, s99

    s_mul_i32 s92, s7, 5
    s_add_u32 s92, s92, 4
    s_mul_i32 s93, s92, 43
    s_lshr_b32 s93, s93, 7
    s_mul_i32 s98, s93, 3
    s_sub_u32 s92, s92, s98
    s_lshl_b32 s98, s93, 1
    s_add_u32 s99, s98, 28
    s_add_u32 s98, s98, s92
    s_lshl_b32 s98, s98, 1
    s_cmp_lt_u32 s92, 2
    s_cselect_b32 s96, s98, s99

    v_lshlrev_b32 v38, 4, v2
    s_lshl_b32 s92, s6, 2
    s_add_u32 s92, s92, s3
    s_mul_i32 s92, s92, 40

    s_add_u32 s40, s40, s92
    s_lshl_b32 s40, s40, 10
    s_add_u32 s41, s41, s92
    s_lshl_b32 s41, s41, 10
    s_add_u32 s42, s42, s92
    s_lshl_b32 s42, s42, 10
    s_add_u32 s95, s95, s92
    s_lshl_b32 s95, s95, 10
    s_add_u32 s96, s96, s92
    s_lshl_b32 s96, s96, 10
    v_lshlrev_b32 v28, 4, v2
    v_add_u32 v28, s6, v28
    v_lshlrev_b32 v28, 7, v28
    s_lshl_b32 s92, s7, 3
    s_add_u32 s92, s92, 65536
    v_add_u32 v28, s92, v28
    s_lshl_b32 s92, s36, 3
    s_add_u32 s92, s92, 98304
    v_mov_b32 v29, s92
    v_cmp_eq_u32 vcc, 14, v2
    s_nop 1
    v_cndmask_b32 v28, v28, v29, vcc

    s_waitcnt vmcnt(9)
    s_barrier
    ds_read_b128 a[0:3], v32 offset:0
    ds_read_b128 a[4:7], v33 offset:0
    ds_read_b128 a[8:11], v34 offset:0
    ds_read_b128 a[12:15], v35 offset:0
    ds_read_b64_tr_b16 v[40:41], v36 offset:0
    ds_read_b64_tr_b16 v[42:43], v36 offset:1280
    ds_read_b64_tr_b16 v[44:45], v36 offset:64
    ds_read_b64_tr_b16 v[46:47], v36 offset:1344
    ds_read_b64_tr_b16 v[48:49], v36 offset:128
    ds_read_b64_tr_b16 v[50:51], v36 offset:1408
    ds_read_b64_tr_b16 v[52:53], v36 offset:192
    ds_read_b64_tr_b16 v[54:55], v36 offset:1472
    ds_read_b64_tr_b16 v[56:57], v36 offset:256
    ds_read_b64_tr_b16 v[58:59], v36 offset:1536
    s_waitcnt lgkmcnt(0)
    ds_read_b64_tr_b16 v[60:61], v36 offset:5120
    ds_read_b64_tr_b16 v[62:63], v36 offset:6400
    ds_read_b64_tr_b16 v[64:65], v36 offset:5184
    ds_read_b64_tr_b16 v[66:67], v36 offset:6464
    ds_read_b64_tr_b16 v[68:69], v36 offset:5248
    ds_read_b64_tr_b16 v[70:71], v36 offset:6528
    ds_read_b64_tr_b16 v[72:73], v36 offset:5312
    ds_read_b64_tr_b16 v[74:75], v36 offset:6592
    ds_read_b64_tr_b16 v[76:77], v36 offset:5376
    ds_read_b64_tr_b16 v[78:79], v36 offset:6656
    s_waitcnt vmcnt(5)
    s_waitcnt lgkmcnt(10)
    v_mfma_f32_32x32x16_bf16 v[128:143], v[40:43], a[0:3], 0
    ds_read_b128 a[16:19], v32 offset:4096
    ds_read_b64_tr_b16 v[80:81], v36 offset:10240
    ds_read_b64_tr_b16 v[82:83], v36 offset:11520
    ds_read_b64_tr_b16 v[84:85], v36 offset:10304
    v_mfma_f32_32x32x16_bf16 v[144:159], v[44:47], a[0:3], 0
    s_add_u32 m0, s26, 8192
    s_nop 0
    buffer_load_dwordx4 v16, s[8:11], s24 offen offset:0 lds
    ds_read_b64_tr_b16 v[86:87], v36 offset:11584
    ds_read_b64_tr_b16 v[88:89], v36 offset:10368
    v_mfma_f32_32x32x16_bf16 v[160:175], v[48:51], a[0:3], 0
    ds_read_b64_tr_b16 v[90:91], v36 offset:11648
    ds_read_b64_tr_b16 v[92:93], v36 offset:10432
    buffer_load_dwordx4 v17, s[8:11], s24 offen offset:1024 lds
    v_mfma_f32_32x32x16_bf16 v[176:191], v[52:55], a[0:3], 0
    ds_read_b64_tr_b16 v[94:95], v36 offset:11712
    ds_read_b64_tr_b16 v[96:97], v36 offset:10496
    ds_read_b64_tr_b16 v[98:99], v36 offset:11776
    v_mfma_f32_32x32x16_bf16 v[192:207], v[56:59], a[0:3], 0
    buffer_load_dwordx4 v18, s[8:11], s24 offen offset:2048 lds
    buffer_load_dwordx4 v19, s[8:11], s24 offen offset:3072 lds
    s_add_u32 s24, s24, 128
    s_add_u32 s28, s28, 1
    s_cmp_eq_u32 s28, 10
    s_cselect_b32 s93, 1280, 0
    s_sub_u32 s24, s24, s93
    s_add_u32 m0, s27, 40960
    s_nop 0
    buffer_load_dwordx4 v20, s[12:15], s25 offen offset:0 lds
    s_waitcnt lgkmcnt(11)
    v_mfma_f32_32x32x16_bf16 v[128:143], v[60:63], a[4:7], v[128:143]
    ds_read_b128 a[20:23], v33 offset:4096
    ds_read_b64_tr_b16 v[40:41], v36 offset:15360
    ds_read_b64_tr_b16 v[42:43], v36 offset:16640
    v_mfma_f32_32x32x16_bf16 v[144:159], v[64:67], a[4:7], v[144:159]
    ds_read_b64_tr_b16 v[44:45], v36 offset:15424
    buffer_load_dwordx4 v21, s[12:15], s25 offen offset:1024 lds
    ds_read_b64_tr_b16 v[46:47], v36 offset:16704
    v_mfma_f32_32x32x16_bf16 v[160:175], v[68:71], a[4:7], v[160:175]
    ds_read_b64_tr_b16 v[48:49], v36 offset:15488
    ds_read_b64_tr_b16 v[50:51], v36 offset:16768
    ds_read_b64_tr_b16 v[52:53], v36 offset:15552
    v_mfma_f32_32x32x16_bf16 v[176:191], v[72:75], a[4:7], v[176:191]
    buffer_load_dwordx4 v22, s[12:15], s25 offen offset:2048 lds
    ds_read_b64_tr_b16 v[54:55], v36 offset:16832
    ds_read_b64_tr_b16 v[56:57], v36 offset:15616
    v_mfma_f32_32x32x16_bf16 v[192:207], v[76:79], a[4:7], v[192:207]
    ds_read_b64_tr_b16 v[58:59], v36 offset:16896
    buffer_load_dwordx4 v23, s[12:15], s25 offen offset:3072 lds
    s_add_u32 m0, s27, 45056
    s_nop 0
    buffer_load_dwordx4 v24, s[12:15], s25 offen offset:0 lds
    s_add_u32 s25, s25, 81920
    s_add_u32 s29, s29, 1
    s_cmp_eq_u32 s29, 10
    s_cselect_b32 s93, 819200, 0
    s_sub_u32 s25, s25, s93
    s_waitcnt vmcnt(9)
    s_barrier
    s_waitcnt lgkmcnt(11)
    v_mfma_f32_32x32x16_bf16 v[128:143], v[80:83], a[8:11], v[128:143]
    ds_read_b128 a[24:27], v34 offset:4096
    ds_read_b64_tr_b16 v[60:61], v36 offset:20480
    ds_read_b64_tr_b16 v[62:63], v36 offset:21760
    v_mfma_f32_32x32x16_bf16 v[144:159], v[84:87], a[8:11], v[144:159]
    ds_read_b64_tr_b16 v[64:65], v36 offset:20544
    s_add_u32 m0, s26, 12288
    s_nop 0
    buffer_load_dwordx4 v16, s[8:11], s24 offen offset:0 lds
    ds_read_b64_tr_b16 v[66:67], v36 offset:21824
    v_mfma_f32_32x32x16_bf16 v[160:175], v[88:91], a[8:11], v[160:175]
    ds_read_b64_tr_b16 v[68:69], v36 offset:20608
    ds_read_b64_tr_b16 v[70:71], v36 offset:21888
    ds_read_b64_tr_b16 v[72:73], v36 offset:20672
    v_mfma_f32_32x32x16_bf16 v[176:191], v[92:95], a[8:11], v[176:191]
    buffer_load_dwordx4 v17, s[8:11], s24 offen offset:1024 lds
    ds_read_b64_tr_b16 v[74:75], v36 offset:21952
    ds_read_b64_tr_b16 v[76:77], v36 offset:20736
    v_mfma_f32_32x32x16_bf16 v[192:207], v[96:99], a[8:11], v[192:207]
    ds_read_b64_tr_b16 v[78:79], v36 offset:22016
    buffer_load_dwordx4 v18, s[8:11], s24 offen offset:2048 lds
    buffer_load_dwordx4 v19, s[8:11], s24 offen offset:3072 lds
    s_add_u32 s24, s24, 128
    s_add_u32 s28, s28, 1
    s_cmp_eq_u32 s28, 10
    s_cselect_b32 s93, 1280, 0
    s_sub_u32 s24, s24, s93
    s_waitcnt lgkmcnt(11)
    v_mfma_f32_32x32x16_bf16 v[128:143], v[40:43], a[12:15], v[128:143]
    ds_read_b128 a[28:31], v35 offset:4096
    ds_read_b64_tr_b16 v[80:81], v36 offset:25600
    ds_read_b64_tr_b16 v[82:83], v36 offset:26880
    ds_read_b64_tr_b16 v[84:85], v36 offset:25664
    v_mfma_f32_32x32x16_bf16 v[144:159], v[44:47], a[12:15], v[144:159]
    s_add_u32 m0, s27, 61440
    s_nop 0
    buffer_load_dwordx4 v20, s[12:15], s25 offen offset:0 lds
    ds_read_b64_tr_b16 v[86:87], v36 offset:26944
    ds_read_b64_tr_b16 v[88:89], v36 offset:25728
    v_mfma_f32_32x32x16_bf16 v[160:175], v[48:51], a[12:15], v[160:175]
    ds_read_b64_tr_b16 v[90:91], v36 offset:27008
    ds_read_b64_tr_b16 v[92:93], v36 offset:25792
    buffer_load_dwordx4 v21, s[12:15], s25 offen offset:1024 lds
    v_mfma_f32_32x32x16_bf16 v[176:191], v[52:55], a[12:15], v[176:191]
    ds_read_b64_tr_b16 v[94:95], v36 offset:27072
    ds_read_b64_tr_b16 v[96:97], v36 offset:25856
    ds_read_b64_tr_b16 v[98:99], v36 offset:27136
    v_mfma_f32_32x32x16_bf16 v[192:207], v[56:59], a[12:15], v[192:207]
    buffer_load_dwordx4 v22, s[12:15], s25 offen offset:2048 lds
    buffer_load_dwordx4 v23, s[12:15], s25 offen offset:3072 lds
    s_add_u32 m0, s27, 65536
    s_nop 0
    buffer_load_dwordx4 v24, s[12:15], s25 offen offset:0 lds
    s_add_u32 s25, s25, 81920
    s_add_u32 s29, s29, 1
    s_cmp_eq_u32 s29, 10
    s_cselect_b32 s93, 819200, 0
    s_sub_u32 s25, s25, s93
    s_waitcnt vmcnt(14)
    s_waitcnt lgkmcnt(10)
    v_mfma_f32_32x32x16_bf16 v[128:143], v[60:63], a[16:19], v[128:143]
    ds_read_b128 a[0:3], v32 offset:8192
    ds_read_b64_tr_b16 v[40:41], v36 offset:30720
    ds_read_b64_tr_b16 v[42:43], v36 offset:32000
    v_mfma_f32_32x32x16_bf16 v[144:159], v[64:67], a[16:19], v[144:159]
    ds_read_b64_tr_b16 v[44:45], v36 offset:30784
    s_add_u32 m0, s26, 0
    s_nop 0
    buffer_load_dwordx4 v16, s[8:11], s24 offen offset:0 lds
    ds_read_b64_tr_b16 v[46:47], v36 offset:32064
    v_mfma_f32_32x32x16_bf16 v[160:175], v[68:71], a[16:19], v[160:175]
    ds_read_b64_tr_b16 v[48:49], v36 offset:30848
    ds_read_b64_tr_b16 v[50:51], v36 offset:32128
    v_mfma_f32_32x32x16_bf16 v[176:191], v[72:75], a[16:19], v[176:191]
    ds_read_b64_tr_b16 v[52:53], v36 offset:30912
    buffer_load_dwordx4 v17, s[8:11], s24 offen offset:1024 lds
    ds_read_b64_tr_b16 v[54:55], v36 offset:32192
    v_mfma_f32_32x32x16_bf16 v[192:207], v[76:79], a[16:19], v[192:207]
    ds_read_b64_tr_b16 v[56:57], v36 offset:30976
    ds_read_b64_tr_b16 v[58:59], v36 offset:32256
    s_waitcnt lgkmcnt(11)
    v_mfma_f32_32x32x16_bf16 v[128:143], v[80:83], a[20:23], v[128:143]
    ds_read_b128 a[4:7], v33 offset:8192
    ds_read_b64_tr_b16 v[60:61], v36 offset:35840
    ds_read_b64_tr_b16 v[62:63], v36 offset:37120
    v_mfma_f32_32x32x16_bf16 v[144:159], v[84:87], a[20:23], v[144:159]
    ds_read_b64_tr_b16 v[64:65], v36 offset:35904
    buffer_load_dwordx4 v18, s[8:11], s24 offen offset:2048 lds
    ds_read_b64_tr_b16 v[66:67], v36 offset:37184
    v_mfma_f32_32x32x16_bf16 v[160:175], v[88:91], a[20:23], v[160:175]
    ds_read_b64_tr_b16 v[68:69], v36 offset:35968
    ds_read_b64_tr_b16 v[70:71], v36 offset:37248
    v_mfma_f32_32x32x16_bf16 v[176:191], v[92:95], a[20:23], v[176:191]
    ds_read_b64_tr_b16 v[72:73], v36 offset:36032
    buffer_load_dwordx4 v19, s[8:11], s24 offen offset:3072 lds
    s_add_u32 s24, s24, 128
    s_add_u32 s28, s28, 1
    s_cmp_eq_u32 s28, 10
    s_cselect_b32 s93, 1280, 0
    s_sub_u32 s24, s24, s93
    ds_read_b64_tr_b16 v[74:75], v36 offset:37312
    v_mfma_f32_32x32x16_bf16 v[192:207], v[96:99], a[20:23], v[192:207]
    ds_read_b64_tr_b16 v[76:77], v36 offset:36096
    ds_read_b64_tr_b16 v[78:79], v36 offset:37376
    s_waitcnt vmcnt(13)
    s_barrier
    s_waitcnt lgkmcnt(11)
    v_mfma_f32_32x32x16_bf16 v[128:143], v[40:43], a[24:27], v[128:143]
    ds_read_b128 a[8:11], v34 offset:8192
    ds_read_b64_tr_b16 v[80:81], v37 offset:0
    ds_read_b64_tr_b16 v[82:83], v37 offset:1280
    v_mfma_f32_32x32x16_bf16 v[144:159], v[44:47], a[24:27], v[144:159]
    ds_read_b64_tr_b16 v[84:85], v37 offset:64
    s_add_u32 m0, s27, 0
    s_nop 0
    buffer_load_dwordx4 v20, s[12:15], s25 offen offset:0 lds
    ds_read_b64_tr_b16 v[86:87], v37 offset:1344
    v_mfma_f32_32x32x16_bf16 v[160:175], v[48:51], a[24:27], v[160:175]
    ds_read_b64_tr_b16 v[88:89], v37 offset:128
    ds_read_b64_tr_b16 v[90:91], v37 offset:1408
    v_mfma_f32_32x32x16_bf16 v[176:191], v[52:55], a[24:27], v[176:191]
    ds_read_b64_tr_b16 v[92:93], v37 offset:192
    buffer_load_dwordx4 v21, s[12:15], s25 offen offset:1024 lds
    ds_read_b64_tr_b16 v[94:95], v37 offset:1472
    v_mfma_f32_32x32x16_bf16 v[192:207], v[56:59], a[24:27], v[192:207]
    ds_read_b64_tr_b16 v[96:97], v37 offset:256
    ds_read_b64_tr_b16 v[98:99], v37 offset:1536
    s_waitcnt lgkmcnt(11)
    v_mfma_f32_32x32x16_bf16 v[128:143], v[60:63], a[28:31], v[128:143]
    ds_read_b128 a[12:15], v35 offset:8192
    ds_read_b64_tr_b16 v[40:41], v37 offset:5120
    ds_read_b64_tr_b16 v[42:43], v37 offset:6400
    v_mfma_f32_32x32x16_bf16 v[144:159], v[64:67], a[28:31], v[144:159]
    ds_read_b64_tr_b16 v[44:45], v37 offset:5184
    buffer_load_dwordx4 v22, s[12:15], s25 offen offset:2048 lds
    ds_read_b64_tr_b16 v[46:47], v37 offset:6464
    v_mfma_f32_32x32x16_bf16 v[160:175], v[68:71], a[28:31], v[160:175]
    ds_read_b64_tr_b16 v[48:49], v37 offset:5248
    ds_read_b64_tr_b16 v[50:51], v37 offset:6528
    ds_read_b64_tr_b16 v[52:53], v37 offset:5312
    v_mfma_f32_32x32x16_bf16 v[176:191], v[72:75], a[28:31], v[176:191]
    buffer_load_dwordx4 v23, s[12:15], s25 offen offset:3072 lds
    ds_read_b64_tr_b16 v[54:55], v37 offset:6592
    ds_read_b64_tr_b16 v[56:57], v37 offset:5376
    v_mfma_f32_32x32x16_bf16 v[192:207], v[76:79], a[28:31], v[192:207]
    ds_read_b64_tr_b16 v[58:59], v37 offset:6656
    s_add_u32 m0, s27, 4096
    s_nop 0
    buffer_load_dwordx4 v24, s[12:15], s25 offen offset:0 lds
    s_add_u32 s25, s25, 81920
    s_add_u32 s29, s29, 1
    s_cmp_eq_u32 s29, 10
    s_cselect_b32 s93, 819200, 0
    s_sub_u32 s25, s25, s93
    s_waitcnt vmcnt(14)
    s_waitcnt lgkmcnt(10)
    v_mfma_f32_32x32x16_bf16 v[128:143], v[80:83], a[0:3], v[128:143]
    ds_read_b128 a[16:19], v32 offset:12288
    ds_read_b64_tr_b16 v[60:61], v37 offset:10240
    ds_read_b64_tr_b16 v[62:63], v37 offset:11520
    v_mfma_f32_32x32x16_bf16 v[144:159], v[84:87], a[0:3], v[144:159]
    ds_read_b64_tr_b16 v[64:65], v37 offset:10304
    s_add_u32 m0, s26, 4096
    s_nop 0
    buffer_load_dwordx4 v16, s[8:11], s24 offen offset:0 lds
    ds_read_b64_tr_b16 v[66:67], v37 offset:11584
    v_mfma_f32_32x32x16_bf16 v[160:175], v[88:91], a[0:3], v[160:175]
    ds_read_b64_tr_b16 v[68:69], v37 offset:10368
    ds_read_b64_tr_b16 v[70:71], v37 offset:11648
    v_mfma_f32_32x32x16_bf16 v[176:191], v[92:95], a[0:3], v[176:191]
    ds_read_b64_tr_b16 v[72:73], v37 offset:10432
    buffer_load_dwordx4 v17, s[8:11], s24 offen offset:1024 lds
    ds_read_b64_tr_b16 v[74:75], v37 offset:11712
    v_mfma_f32_32x32x16_bf16 v[192:207], v[96:99], a[0:3], v[192:207]
    ds_read_b64_tr_b16 v[76:77], v37 offset:10496
    ds_read_b64_tr_b16 v[78:79], v37 offset:11776
    s_waitcnt lgkmcnt(11)
    v_mfma_f32_32x32x16_bf16 v[128:143], v[40:43], a[4:7], v[128:143]
    ds_read_b128 a[20:23], v33 offset:12288
    ds_read_b64_tr_b16 v[80:81], v37 offset:15360
    ds_read_b64_tr_b16 v[82:83], v37 offset:16640
    v_mfma_f32_32x32x16_bf16 v[144:159], v[44:47], a[4:7], v[144:159]
    ds_read_b64_tr_b16 v[84:85], v37 offset:15424
    buffer_load_dwordx4 v18, s[8:11], s24 offen offset:2048 lds
    ds_read_b64_tr_b16 v[86:87], v37 offset:16704
    v_mfma_f32_32x32x16_bf16 v[160:175], v[48:51], a[4:7], v[160:175]
    ds_read_b64_tr_b16 v[88:89], v37 offset:15488
    ds_read_b64_tr_b16 v[90:91], v37 offset:16768
    v_mfma_f32_32x32x16_bf16 v[176:191], v[52:55], a[4:7], v[176:191]
    ds_read_b64_tr_b16 v[92:93], v37 offset:15552
    buffer_load_dwordx4 v19, s[8:11], s24 offen offset:3072 lds
    s_add_u32 s24, s24, 128
    s_add_u32 s28, s28, 1
    s_cmp_eq_u32 s28, 10
    s_cselect_b32 s93, 1280, 0
    s_sub_u32 s24, s24, s93
    ds_read_b64_tr_b16 v[94:95], v37 offset:16832
    v_mfma_f32_32x32x16_bf16 v[192:207], v[56:59], a[4:7], v[192:207]
    ds_read_b64_tr_b16 v[96:97], v37 offset:15616
    ds_read_b64_tr_b16 v[98:99], v37 offset:16896
    s_waitcnt vmcnt(13)
    s_barrier
    s_waitcnt lgkmcnt(11)
    v_mfma_f32_32x32x16_bf16 v[128:143], v[60:63], a[8:11], v[128:143]
    ds_read_b128 a[24:27], v34 offset:12288
    ds_read_b64_tr_b16 v[40:41], v37 offset:20480
    ds_read_b64_tr_b16 v[42:43], v37 offset:21760
    v_mfma_f32_32x32x16_bf16 v[144:159], v[64:67], a[8:11], v[144:159]
    ds_read_b64_tr_b16 v[44:45], v37 offset:20544
    s_add_u32 m0, s27, 20480
    s_nop 0
    buffer_load_dwordx4 v20, s[12:15], s25 offen offset:0 lds
    ds_read_b64_tr_b16 v[46:47], v37 offset:21824
    v_mfma_f32_32x32x16_bf16 v[160:175], v[68:71], a[8:11], v[160:175]
    ds_read_b64_tr_b16 v[48:49], v37 offset:20608
    ds_read_b64_tr_b16 v[50:51], v37 offset:21888
    v_mfma_f32_32x32x16_bf16 v[176:191], v[72:75], a[8:11], v[176:191]
    ds_read_b64_tr_b16 v[52:53], v37 offset:20672
    buffer_load_dwordx4 v21, s[12:15], s25 offen offset:1024 lds
    ds_read_b64_tr_b16 v[54:55], v37 offset:21952
    v_mfma_f32_32x32x16_bf16 v[192:207], v[76:79], a[8:11], v[192:207]
    ds_read_b64_tr_b16 v[56:57], v37 offset:20736
    ds_read_b64_tr_b16 v[58:59], v37 offset:22016
    s_waitcnt lgkmcnt(11)
    v_mfma_f32_32x32x16_bf16 v[128:143], v[80:83], a[12:15], v[128:143]
    ds_read_b128 a[28:31], v35 offset:12288
    ds_read_b64_tr_b16 v[60:61], v37 offset:25600
    ds_read_b64_tr_b16 v[62:63], v37 offset:26880
    v_mfma_f32_32x32x16_bf16 v[144:159], v[84:87], a[12:15], v[144:159]
    ds_read_b64_tr_b16 v[64:65], v37 offset:25664
    buffer_load_dwordx4 v22, s[12:15], s25 offen offset:2048 lds
    ds_read_b64_tr_b16 v[66:67], v37 offset:26944
    v_mfma_f32_32x32x16_bf16 v[160:175], v[88:91], a[12:15], v[160:175]
    ds_read_b64_tr_b16 v[68:69], v37 offset:25728
    ds_read_b64_tr_b16 v[70:71], v37 offset:27008
    ds_read_b64_tr_b16 v[72:73], v37 offset:25792
    v_mfma_f32_32x32x16_bf16 v[176:191], v[92:95], a[12:15], v[176:191]
    buffer_load_dwordx4 v23, s[12:15], s25 offen offset:3072 lds
    ds_read_b64_tr_b16 v[74:75], v37 offset:27072
    ds_read_b64_tr_b16 v[76:77], v37 offset:25856
    v_mfma_f32_32x32x16_bf16 v[192:207], v[96:99], a[12:15], v[192:207]
    ds_read_b64_tr_b16 v[78:79], v37 offset:27136
    s_add_u32 m0, s27, 24576
    s_nop 0
    buffer_load_dwordx4 v24, s[12:15], s25 offen offset:0 lds
    s_add_u32 s25, s25, 81920
    s_add_u32 s29, s29, 1
    s_cmp_eq_u32 s29, 10
    s_cselect_b32 s93, 819200, 0
    s_sub_u32 s25, s25, s93
    s_waitcnt vmcnt(14)
    s_waitcnt lgkmcnt(10)
    v_mfma_f32_32x32x16_bf16 v[128:143], v[40:43], a[16:19], v[128:143]
    ds_read_b128 a[0:3], v32 offset:0
    ds_read_b64_tr_b16 v[80:81], v37 offset:30720
    ds_read_b64_tr_b16 v[82:83], v37 offset:32000
    v_mfma_f32_32x32x16_bf16 v[144:159], v[44:47], a[16:19], v[144:159]
    ds_read_b64_tr_b16 v[84:85], v37 offset:30784
    s_add_u32 m0, s26, 8192
    s_nop 0
    buffer_load_dwordx4 v16, s[8:11], s24 offen offset:0 lds
    ds_read_b64_tr_b16 v[86:87], v37 offset:32064
    v_mfma_f32_32x32x16_bf16 v[160:175], v[48:51], a[16:19], v[160:175]
    ds_read_b64_tr_b16 v[88:89], v37 offset:30848
    ds_read_b64_tr_b16 v[90:91], v37 offset:32128
    v_mfma_f32_32x32x16_bf16 v[176:191], v[52:55], a[16:19], v[176:191]
    ds_read_b64_tr_b16 v[92:93], v37 offset:30912
    buffer_load_dwordx4 v17, s[8:11], s24 offen offset:1024 lds
    ds_read_b64_tr_b16 v[94:95], v37 offset:32192
    v_mfma_f32_32x32x16_bf16 v[192:207], v[56:59], a[16:19], v[192:207]
    ds_read_b64_tr_b16 v[96:97], v37 offset:30976
    ds_read_b64_tr_b16 v[98:99], v37 offset:32256
    s_waitcnt lgkmcnt(11)
    v_mfma_f32_32x32x16_bf16 v[128:143], v[60:63], a[20:23], v[128:143]
    ds_read_b128 a[4:7], v33 offset:0
    ds_read_b64_tr_b16 v[40:41], v37 offset:35840
    ds_read_b64_tr_b16 v[42:43], v37 offset:37120
    v_mfma_f32_32x32x16_bf16 v[144:159], v[64:67], a[20:23], v[144:159]
    ds_read_b64_tr_b16 v[44:45], v37 offset:35904
    buffer_load_dwordx4 v18, s[8:11], s24 offen offset:2048 lds
    ds_read_b64_tr_b16 v[46:47], v37 offset:37184
    v_mfma_f32_32x32x16_bf16 v[160:175], v[68:71], a[20:23], v[160:175]
    ds_read_b64_tr_b16 v[48:49], v37 offset:35968
    ds_read_b64_tr_b16 v[50:51], v37 offset:37248
    v_mfma_f32_32x32x16_bf16 v[176:191], v[72:75], a[20:23], v[176:191]
    ds_read_b64_tr_b16 v[52:53], v37 offset:36032
    buffer_load_dwordx4 v19, s[8:11], s24 offen offset:3072 lds
    s_add_u32 s24, s24, 128
    s_add_u32 s28, s28, 1
    s_cmp_eq_u32 s28, 10
    s_cselect_b32 s93, 1280, 0
    s_sub_u32 s24, s24, s93
    ds_read_b64_tr_b16 v[54:55], v37 offset:37312
    v_mfma_f32_32x32x16_bf16 v[192:207], v[76:79], a[20:23], v[192:207]
    ds_read_b64_tr_b16 v[56:57], v37 offset:36096
    ds_read_b64_tr_b16 v[58:59], v37 offset:37376
    s_waitcnt vmcnt(13)
    s_barrier
    s_waitcnt lgkmcnt(11)
    v_mfma_f32_32x32x16_bf16 v[128:143], v[80:83], a[24:27], v[128:143]
    ds_read_b128 a[8:11], v34 offset:0
    ds_read_b64_tr_b16 v[60:61], v36 offset:0
    ds_read_b64_tr_b16 v[62:63], v36 offset:1280
    v_mfma_f32_32x32x16_bf16 v[144:159], v[84:87], a[24:27], v[144:159]
    ds_read_b64_tr_b16 v[64:65], v36 offset:64
    s_add_u32 m0, s27, 40960
    s_nop 0
    buffer_load_dwordx4 v20, s[12:15], s25 offen offset:0 lds
    ds_read_b64_tr_b16 v[66:67], v36 offset:1344
    v_mfma_f32_32x32x16_bf16 v[160:175], v[88:91], a[24:27], v[160:175]
    ds_read_b64_tr_b16 v[68:69], v36 offset:128
    ds_read_b64_tr_b16 v[70:71], v36 offset:1408
    v_mfma_f32_32x32x16_bf16 v[176:191], v[92:95], a[24:27], v[176:191]
    ds_read_b64_tr_b16 v[72:73], v36 offset:192
    buffer_load_dwordx4 v21, s[12:15], s25 offen offset:1024 lds
    ds_read_b64_tr_b16 v[74:75], v36 offset:1472
    v_mfma_f32_32x32x16_bf16 v[192:207], v[96:99], a[24:27], v[192:207]
    ds_read_b64_tr_b16 v[76:77], v36 offset:256
    ds_read_b64_tr_b16 v[78:79], v36 offset:1536
    s_waitcnt lgkmcnt(11)
    v_mfma_f32_32x32x16_bf16 v[128:143], v[40:43], a[28:31], v[128:143]
    ds_read_b128 a[12:15], v35 offset:0
    ds_read_b64_tr_b16 v[80:81], v36 offset:5120
    ds_read_b64_tr_b16 v[82:83], v36 offset:6400
    v_mfma_f32_32x32x16_bf16 v[144:159], v[44:47], a[28:31], v[144:159]
    ds_read_b64_tr_b16 v[84:85], v36 offset:5184
    buffer_load_dwordx4 v22, s[12:15], s25 offen offset:2048 lds
    ds_read_b64_tr_b16 v[86:87], v36 offset:6464
    v_mfma_f32_32x32x16_bf16 v[160:175], v[48:51], a[28:31], v[160:175]
    ds_read_b64_tr_b16 v[88:89], v36 offset:5248
    ds_read_b64_tr_b16 v[90:91], v36 offset:6528
    ds_read_b64_tr_b16 v[92:93], v36 offset:5312
    v_mfma_f32_32x32x16_bf16 v[176:191], v[52:55], a[28:31], v[176:191]
    buffer_load_dwordx4 v23, s[12:15], s25 offen offset:3072 lds
    ds_read_b64_tr_b16 v[94:95], v36 offset:6592
    ds_read_b64_tr_b16 v[96:97], v36 offset:5376
    v_mfma_f32_32x32x16_bf16 v[192:207], v[56:59], a[28:31], v[192:207]
    ds_read_b64_tr_b16 v[98:99], v36 offset:6656
    s_add_u32 m0, s27, 45056
    s_nop 0
    buffer_load_dwordx4 v24, s[12:15], s25 offen offset:0 lds
    s_add_u32 s25, s25, 81920
    s_add_u32 s29, s29, 1
    s_cmp_eq_u32 s29, 10
    s_cselect_b32 s93, 819200, 0
    s_sub_u32 s25, s25, s93
    s_waitcnt vmcnt(14)
    s_waitcnt lgkmcnt(10)
    v_mfma_f32_32x32x16_bf16 v[128:143], v[60:63], a[0:3], v[128:143]
    ds_read_b128 a[16:19], v32 offset:4096
    ds_read_b64_tr_b16 v[40:41], v36 offset:10240
    ds_read_b64_tr_b16 v[42:43], v36 offset:11520
    v_mfma_f32_32x32x16_bf16 v[144:159], v[64:67], a[0:3], v[144:159]
    ds_read_b64_tr_b16 v[44:45], v36 offset:10304
    s_add_u32 m0, s26, 12288
    s_nop 0
    buffer_load_dwordx4 v16, s[8:11], s24 offen offset:0 lds
    ds_read_b64_tr_b16 v[46:47], v36 offset:11584
    v_mfma_f32_32x32x16_bf16 v[160:175], v[68:71], a[0:3], v[160:175]
    ds_read_b64_tr_b16 v[48:49], v36 offset:10368
    ds_read_b64_tr_b16 v[50:51], v36 offset:11648
    v_mfma_f32_32x32x16_bf16 v[176:191], v[72:75], a[0:3], v[176:191]
    ds_read_b64_tr_b16 v[52:53], v36 offset:10432
    buffer_load_dwordx4 v17, s[8:11], s24 offen offset:1024 lds
    ds_read_b64_tr_b16 v[54:55], v36 offset:11712
    v_mfma_f32_32x32x16_bf16 v[192:207], v[76:79], a[0:3], v[192:207]
    ds_read_b64_tr_b16 v[56:57], v36 offset:10496
    ds_read_b64_tr_b16 v[58:59], v36 offset:11776
    s_waitcnt lgkmcnt(11)
    v_mfma_f32_32x32x16_bf16 v[128:143], v[80:83], a[4:7], v[128:143]
    ds_read_b128 a[20:23], v33 offset:4096
    ds_read_b64_tr_b16 v[60:61], v36 offset:15360
    ds_read_b64_tr_b16 v[62:63], v36 offset:16640
    v_mfma_f32_32x32x16_bf16 v[144:159], v[84:87], a[4:7], v[144:159]
    ds_read_b64_tr_b16 v[64:65], v36 offset:15424
    buffer_load_dwordx4 v18, s[8:11], s24 offen offset:2048 lds
    ds_read_b64_tr_b16 v[66:67], v36 offset:16704
    v_mfma_f32_32x32x16_bf16 v[160:175], v[88:91], a[4:7], v[160:175]
    ds_read_b64_tr_b16 v[68:69], v36 offset:15488
    ds_read_b64_tr_b16 v[70:71], v36 offset:16768
    v_mfma_f32_32x32x16_bf16 v[176:191], v[92:95], a[4:7], v[176:191]
    ds_read_b64_tr_b16 v[72:73], v36 offset:15552
    buffer_load_dwordx4 v19, s[8:11], s24 offen offset:3072 lds
    s_add_u32 s24, s24, 128
    s_add_u32 s28, s28, 1
    s_cmp_eq_u32 s28, 10
    s_cselect_b32 s93, 1280, 0
    s_sub_u32 s24, s24, s93
    ds_read_b64_tr_b16 v[74:75], v36 offset:16832
    v_mfma_f32_32x32x16_bf16 v[192:207], v[96:99], a[4:7], v[192:207]
    ds_read_b64_tr_b16 v[76:77], v36 offset:15616
    ds_read_b64_tr_b16 v[78:79], v36 offset:16896
    s_waitcnt vmcnt(13)
    s_barrier
    s_waitcnt lgkmcnt(11)
    v_mfma_f32_32x32x16_bf16 v[128:143], v[40:43], a[8:11], v[128:143]
    ds_read_b128 a[24:27], v34 offset:4096
    ds_read_b64_tr_b16 v[80:81], v36 offset:20480
    ds_read_b64_tr_b16 v[82:83], v36 offset:21760
    v_mfma_f32_32x32x16_bf16 v[144:159], v[44:47], a[8:11], v[144:159]
    ds_read_b64_tr_b16 v[84:85], v36 offset:20544
    s_add_u32 m0, s27, 61440
    s_nop 0
    buffer_load_dwordx4 v20, s[12:15], s25 offen offset:0 lds
    ds_read_b64_tr_b16 v[86:87], v36 offset:21824
    v_mfma_f32_32x32x16_bf16 v[160:175], v[48:51], a[8:11], v[160:175]
    ds_read_b64_tr_b16 v[88:89], v36 offset:20608
    ds_read_b64_tr_b16 v[90:91], v36 offset:21888
    v_mfma_f32_32x32x16_bf16 v[176:191], v[52:55], a[8:11], v[176:191]
    ds_read_b64_tr_b16 v[92:93], v36 offset:20672
    buffer_load_dwordx4 v21, s[12:15], s25 offen offset:1024 lds
    ds_read_b64_tr_b16 v[94:95], v36 offset:21952
    v_mfma_f32_32x32x16_bf16 v[192:207], v[56:59], a[8:11], v[192:207]
    ds_read_b64_tr_b16 v[96:97], v36 offset:20736
    ds_read_b64_tr_b16 v[98:99], v36 offset:22016
    s_waitcnt lgkmcnt(11)
    v_mfma_f32_32x32x16_bf16 v[128:143], v[60:63], a[12:15], v[128:143]
    ds_read_b128 a[28:31], v35 offset:4096
    ds_read_b64_tr_b16 v[40:41], v36 offset:25600
    ds_read_b64_tr_b16 v[42:43], v36 offset:26880
    v_mfma_f32_32x32x16_bf16 v[144:159], v[64:67], a[12:15], v[144:159]
    ds_read_b64_tr_b16 v[44:45], v36 offset:25664
    buffer_load_dwordx4 v22, s[12:15], s25 offen offset:2048 lds
    ds_read_b64_tr_b16 v[46:47], v36 offset:26944
    v_mfma_f32_32x32x16_bf16 v[160:175], v[68:71], a[12:15], v[160:175]
    ds_read_b64_tr_b16 v[48:49], v36 offset:25728
    ds_read_b64_tr_b16 v[50:51], v36 offset:27008
    ds_read_b64_tr_b16 v[52:53], v36 offset:25792
    v_mfma_f32_32x32x16_bf16 v[176:191], v[72:75], a[12:15], v[176:191]
    buffer_load_dwordx4 v23, s[12:15], s25 offen offset:3072 lds
    ds_read_b64_tr_b16 v[54:55], v36 offset:27072
    ds_read_b64_tr_b16 v[56:57], v36 offset:25856
    v_mfma_f32_32x32x16_bf16 v[192:207], v[76:79], a[12:15], v[192:207]
    ds_read_b64_tr_b16 v[58:59], v36 offset:27136
    s_add_u32 m0, s27, 65536
    s_nop 0
    buffer_load_dwordx4 v24, s[12:15], s25 offen offset:0 lds
    s_add_u32 s25, s25, 81920
    s_add_u32 s29, s29, 1
    s_cmp_eq_u32 s29, 10
    s_cselect_b32 s93, 819200, 0
    s_sub_u32 s25, s25, s93
    s_waitcnt vmcnt(14)
    s_waitcnt lgkmcnt(10)
    v_mfma_f32_32x32x16_bf16 v[128:143], v[80:83], a[16:19], v[128:143]
    ds_read_b128 a[0:3], v32 offset:8192
    ds_read_b64_tr_b16 v[60:61], v36 offset:30720
    ds_read_b64_tr_b16 v[62:63], v36 offset:32000
    v_mfma_f32_32x32x16_bf16 v[144:159], v[84:87], a[16:19], v[144:159]
    ds_read_b64_tr_b16 v[64:65], v36 offset:30784
    s_add_u32 m0, s26, 0
    s_nop 0
    buffer_load_dwordx4 v16, s[8:11], s24 offen offset:0 lds
    ds_read_b64_tr_b16 v[66:67], v36 offset:32064
    v_mfma_f32_32x32x16_bf16 v[160:175], v[88:91], a[16:19], v[160:175]
    ds_read_b64_tr_b16 v[68:69], v36 offset:30848
    ds_read_b64_tr_b16 v[70:71], v36 offset:32128
    v_mfma_f32_32x32x16_bf16 v[176:191], v[92:95], a[16:19], v[176:191]
    ds_read_b64_tr_b16 v[72:73], v36 offset:30912
    buffer_load_dwordx4 v17, s[8:11], s24 offen offset:1024 lds
    ds_read_b64_tr_b16 v[74:75], v36 offset:32192
    v_mfma_f32_32x32x16_bf16 v[192:207], v[96:99], a[16:19], v[192:207]
    ds_read_b64_tr_b16 v[76:77], v36 offset:30976
    ds_read_b64_tr_b16 v[78:79], v36 offset:32256
    s_waitcnt lgkmcnt(11)
    v_mfma_f32_32x32x16_bf16 v[128:143], v[40:43], a[20:23], v[128:143]
    ds_read_b128 a[4:7], v33 offset:8192
    ds_read_b64_tr_b16 v[80:81], v36 offset:35840
    ds_read_b64_tr_b16 v[82:83], v36 offset:37120
    v_mfma_f32_32x32x16_bf16 v[144:159], v[44:47], a[20:23], v[144:159]
    ds_read_b64_tr_b16 v[84:85], v36 offset:35904
    buffer_load_dwordx4 v18, s[8:11], s24 offen offset:2048 lds
    ds_read_b64_tr_b16 v[86:87], v36 offset:37184
    v_mfma_f32_32x32x16_bf16 v[160:175], v[48:51], a[20:23], v[160:175]
    ds_read_b64_tr_b16 v[88:89], v36 offset:35968
    ds_read_b64_tr_b16 v[90:91], v36 offset:37248
    v_mfma_f32_32x32x16_bf16 v[176:191], v[52:55], a[20:23], v[176:191]
    ds_read_b64_tr_b16 v[92:93], v36 offset:36032
    buffer_load_dwordx4 v19, s[8:11], s24 offen offset:3072 lds
    s_add_u32 s24, s24, 128
    s_add_u32 s28, s28, 1
    s_cmp_eq_u32 s28, 10
    s_cselect_b32 s93, 1280, 0
    s_sub_u32 s24, s24, s93
    ds_read_b64_tr_b16 v[94:95], v36 offset:37312
    v_mfma_f32_32x32x16_bf16 v[192:207], v[56:59], a[20:23], v[192:207]
    ds_read_b64_tr_b16 v[96:97], v36 offset:36096
    ds_read_b64_tr_b16 v[98:99], v36 offset:37376
    s_waitcnt vmcnt(13)
    s_barrier
    s_waitcnt lgkmcnt(11)
    v_mfma_f32_32x32x16_bf16 v[128:143], v[60:63], a[24:27], v[128:143]
    ds_read_b128 a[8:11], v34 offset:8192
    ds_read_b64_tr_b16 v[40:41], v37 offset:0
    ds_read_b64_tr_b16 v[42:43], v37 offset:1280
    v_mfma_f32_32x32x16_bf16 v[144:159], v[64:67], a[24:27], v[144:159]
    ds_read_b64_tr_b16 v[44:45], v37 offset:64
    s_add_u32 m0, s27, 0
    s_nop 0
    buffer_load_dwordx4 v20, s[12:15], s25 offen offset:0 lds
    ds_read_b64_tr_b16 v[46:47], v37 offset:1344
    v_mfma_f32_32x32x16_bf16 v[160:175], v[68:71], a[24:27], v[160:175]
    ds_read_b64_tr_b16 v[48:49], v37 offset:128
    ds_read_b64_tr_b16 v[50:51], v37 offset:1408
    v_mfma_f32_32x32x16_bf16 v[176:191], v[72:75], a[24:27], v[176:191]
    ds_read_b64_tr_b16 v[52:53], v37 offset:192
    buffer_load_dwordx4 v21, s[12:15], s25 offen offset:1024 lds
    ds_read_b64_tr_b16 v[54:55], v37 offset:1472
    v_mfma_f32_32x32x16_bf16 v[192:207], v[76:79], a[24:27], v[192:207]
    ds_read_b64_tr_b16 v[56:57], v37 offset:256
    ds_read_b64_tr_b16 v[58:59], v37 offset:1536
    s_waitcnt lgkmcnt(11)
    v_mfma_f32_32x32x16_bf16 v[128:143], v[80:83], a[28:31], v[128:143]
    ds_read_b128 a[12:15], v35 offset:8192
    ds_read_b64_tr_b16 v[60:61], v37 offset:5120
    ds_read_b64_tr_b16 v[62:63], v37 offset:6400
    v_mfma_f32_32x32x16_bf16 v[144:159], v[84:87], a[28:31], v[144:159]
    ds_read_b64_tr_b16 v[64:65], v37 offset:5184
    buffer_load_dwordx4 v22, s[12:15], s25 offen offset:2048 lds
    ds_read_b64_tr_b16 v[66:67], v37 offset:6464
    v_mfma_f32_32x32x16_bf16 v[160:175], v[88:91], a[28:31], v[160:175]
    ds_read_b64_tr_b16 v[68:69], v37 offset:5248
    ds_read_b64_tr_b16 v[70:71], v37 offset:6528
    ds_read_b64_tr_b16 v[72:73], v37 offset:5312
    v_mfma_f32_32x32x16_bf16 v[176:191], v[92:95], a[28:31], v[176:191]
    buffer_load_dwordx4 v23, s[12:15], s25 offen offset:3072 lds
    ds_read_b64_tr_b16 v[74:75], v37 offset:6592
    ds_read_b64_tr_b16 v[76:77], v37 offset:5376
    v_mfma_f32_32x32x16_bf16 v[192:207], v[96:99], a[28:31], v[192:207]
    ds_read_b64_tr_b16 v[78:79], v37 offset:6656
    s_add_u32 m0, s27, 4096
    s_nop 0
    buffer_load_dwordx4 v24, s[12:15], s25 offen offset:0 lds
    s_add_u32 s25, s25, 81920
    s_add_u32 s29, s29, 1
    s_cmp_eq_u32 s29, 10
    s_cselect_b32 s93, 819200, 0
    s_sub_u32 s25, s25, s93
    s_waitcnt vmcnt(14)
    s_waitcnt lgkmcnt(10)
    v_mfma_f32_32x32x16_bf16 v[128:143], v[40:43], a[0:3], v[128:143]
    ds_read_b128 a[16:19], v32 offset:12288
    ds_read_b64_tr_b16 v[80:81], v37 offset:10240
    ds_read_b64_tr_b16 v[82:83], v37 offset:11520
    v_mfma_f32_32x32x16_bf16 v[144:159], v[44:47], a[0:3], v[144:159]
    ds_read_b64_tr_b16 v[84:85], v37 offset:10304
    s_add_u32 m0, s26, 4096
    s_nop 0
    buffer_load_dwordx4 v16, s[8:11], s24 offen offset:0 lds
    ds_read_b64_tr_b16 v[86:87], v37 offset:11584
    v_mfma_f32_32x32x16_bf16 v[160:175], v[48:51], a[0:3], v[160:175]
    ds_read_b64_tr_b16 v[88:89], v37 offset:10368
    ds_read_b64_tr_b16 v[90:91], v37 offset:11648
    v_mfma_f32_32x32x16_bf16 v[176:191], v[52:55], a[0:3], v[176:191]
    ds_read_b64_tr_b16 v[92:93], v37 offset:10432
    buffer_load_dwordx4 v17, s[8:11], s24 offen offset:1024 lds
    ds_read_b64_tr_b16 v[94:95], v37 offset:11712
    v_mfma_f32_32x32x16_bf16 v[192:207], v[56:59], a[0:3], v[192:207]
    ds_read_b64_tr_b16 v[96:97], v37 offset:10496
    ds_read_b64_tr_b16 v[98:99], v37 offset:11776
    s_waitcnt lgkmcnt(11)
    v_mfma_f32_32x32x16_bf16 v[128:143], v[60:63], a[4:7], v[128:143]
    ds_read_b128 a[20:23], v33 offset:12288
    ds_read_b64_tr_b16 v[40:41], v37 offset:15360
    ds_read_b64_tr_b16 v[42:43], v37 offset:16640
    v_mfma_f32_32x32x16_bf16 v[144:159], v[64:67], a[4:7], v[144:159]
    ds_read_b64_tr_b16 v[44:45], v37 offset:15424
    buffer_load_dwordx4 v18, s[8:11], s24 offen offset:2048 lds
    ds_read_b64_tr_b16 v[46:47], v37 offset:16704
    v_mfma_f32_32x32x16_bf16 v[160:175], v[68:71], a[4:7], v[160:175]
    ds_read_b64_tr_b16 v[48:49], v37 offset:15488
    ds_read_b64_tr_b16 v[50:51], v37 offset:16768
    v_mfma_f32_32x32x16_bf16 v[176:191], v[72:75], a[4:7], v[176:191]
    ds_read_b64_tr_b16 v[52:53], v37 offset:15552
    buffer_load_dwordx4 v19, s[8:11], s24 offen offset:3072 lds
    s_add_u32 s24, s24, 128
    s_add_u32 s28, s28, 1
    s_cmp_eq_u32 s28, 10
    s_cselect_b32 s93, 1280, 0
    s_sub_u32 s24, s24, s93
    ds_read_b64_tr_b16 v[54:55], v37 offset:16832
    v_mfma_f32_32x32x16_bf16 v[192:207], v[76:79], a[4:7], v[192:207]
    ds_read_b64_tr_b16 v[56:57], v37 offset:15616
    ds_read_b64_tr_b16 v[58:59], v37 offset:16896
    s_waitcnt vmcnt(13)
    s_barrier
    s_waitcnt lgkmcnt(11)
    v_mfma_f32_32x32x16_bf16 v[128:143], v[80:83], a[8:11], v[128:143]
    ds_read_b128 a[24:27], v34 offset:12288
    ds_read_b64_tr_b16 v[60:61], v37 offset:20480
    ds_read_b64_tr_b16 v[62:63], v37 offset:21760
    v_mfma_f32_32x32x16_bf16 v[144:159], v[84:87], a[8:11], v[144:159]
    ds_read_b64_tr_b16 v[64:65], v37 offset:20544
    s_add_u32 m0, s27, 20480
    s_nop 0
    buffer_load_dwordx4 v20, s[12:15], s25 offen offset:0 lds
    ds_read_b64_tr_b16 v[66:67], v37 offset:21824
    v_mfma_f32_32x32x16_bf16 v[160:175], v[88:91], a[8:11], v[160:175]
    ds_read_b64_tr_b16 v[68:69], v37 offset:20608
    ds_read_b64_tr_b16 v[70:71], v37 offset:21888
    v_mfma_f32_32x32x16_bf16 v[176:191], v[92:95], a[8:11], v[176:191]
    ds_read_b64_tr_b16 v[72:73], v37 offset:20672
    buffer_load_dwordx4 v21, s[12:15], s25 offen offset:1024 lds
    ds_read_b64_tr_b16 v[74:75], v37 offset:21952
    v_mfma_f32_32x32x16_bf16 v[192:207], v[96:99], a[8:11], v[192:207]
    ds_read_b64_tr_b16 v[76:77], v37 offset:20736
    ds_read_b64_tr_b16 v[78:79], v37 offset:22016
    s_waitcnt lgkmcnt(11)
    v_mfma_f32_32x32x16_bf16 v[128:143], v[40:43], a[12:15], v[128:143]
    ds_read_b128 a[28:31], v35 offset:12288
    ds_read_b64_tr_b16 v[80:81], v37 offset:25600
    ds_read_b64_tr_b16 v[82:83], v37 offset:26880
    v_mfma_f32_32x32x16_bf16 v[144:159], v[44:47], a[12:15], v[144:159]
    ds_read_b64_tr_b16 v[84:85], v37 offset:25664
    buffer_load_dwordx4 v22, s[12:15], s25 offen offset:2048 lds
    ds_read_b64_tr_b16 v[86:87], v37 offset:26944
    v_mfma_f32_32x32x16_bf16 v[160:175], v[48:51], a[12:15], v[160:175]
    ds_read_b64_tr_b16 v[88:89], v37 offset:25728
    ds_read_b64_tr_b16 v[90:91], v37 offset:27008
    ds_read_b64_tr_b16 v[92:93], v37 offset:25792
    v_mfma_f32_32x32x16_bf16 v[176:191], v[52:55], a[12:15], v[176:191]
    buffer_load_dwordx4 v23, s[12:15], s25 offen offset:3072 lds
    ds_read_b64_tr_b16 v[94:95], v37 offset:27072
    ds_read_b64_tr_b16 v[96:97], v37 offset:25856
    v_mfma_f32_32x32x16_bf16 v[192:207], v[56:59], a[12:15], v[192:207]
    ds_read_b64_tr_b16 v[98:99], v37 offset:27136
    s_add_u32 m0, s27, 24576
    s_nop 0
    buffer_load_dwordx4 v24, s[12:15], s25 offen offset:0 lds
    s_add_u32 s25, s25, 81920
    s_add_u32 s29, s29, 1
    s_cmp_eq_u32 s29, 10
    s_cselect_b32 s93, 819200, 0
    s_sub_u32 s25, s25, s93
    s_waitcnt vmcnt(14)
    s_waitcnt lgkmcnt(10)
    v_mfma_f32_32x32x16_bf16 v[128:143], v[60:63], a[16:19], v[128:143]
    ds_read_b128 a[0:3], v32 offset:0
    ds_read_b64_tr_b16 v[40:41], v37 offset:30720
    ds_read_b64_tr_b16 v[42:43], v37 offset:32000
    v_mfma_f32_32x32x16_bf16 v[144:159], v[64:67], a[16:19], v[144:159]
    ds_read_b64_tr_b16 v[44:45], v37 offset:30784
    ds_read_b64_tr_b16 v[46:47], v37 offset:32064
    v_mfma_f32_32x32x16_bf16 v[160:175], v[68:71], a[16:19], v[160:175]
    ds_read_b64_tr_b16 v[48:49], v37 offset:30848
    ds_read_b64_tr_b16 v[50:51], v37 offset:32128
    v_mfma_f32_32x32x16_bf16 v[176:191], v[72:75], a[16:19], v[176:191]
    ds_read_b64_tr_b16 v[52:53], v37 offset:30912
    ds_read_b64_tr_b16 v[54:55], v37 offset:32192
    v_mfma_f32_32x32x16_bf16 v[192:207], v[76:79], a[16:19], v[192:207]
    ds_read_b64_tr_b16 v[56:57], v37 offset:30976
    ds_read_b64_tr_b16 v[58:59], v37 offset:32256
    s_waitcnt lgkmcnt(11)
    v_mfma_f32_32x32x16_bf16 v[128:143], v[80:83], a[20:23], v[128:143]
    ds_read_b128 a[4:7], v33 offset:0
    ds_read_b64_tr_b16 v[60:61], v37 offset:35840
    ds_read_b64_tr_b16 v[62:63], v37 offset:37120
    v_mfma_f32_32x32x16_bf16 v[144:159], v[84:87], a[20:23], v[144:159]
    ds_read_b64_tr_b16 v[64:65], v37 offset:35904
    ds_read_b64_tr_b16 v[66:67], v37 offset:37184
    v_mfma_f32_32x32x16_bf16 v[160:175], v[88:91], a[20:23], v[160:175]
    ds_read_b64_tr_b16 v[68:69], v37 offset:35968
    ds_read_b64_tr_b16 v[70:71], v37 offset:37248
    v_mfma_f32_32x32x16_bf16 v[176:191], v[92:95], a[20:23], v[176:191]
    ds_read_b64_tr_b16 v[72:73], v37 offset:36032
    ds_read_b64_tr_b16 v[74:75], v37 offset:37312
    v_mfma_f32_32x32x16_bf16 v[192:207], v[96:99], a[20:23], v[192:207]
    ds_read_b64_tr_b16 v[76:77], v37 offset:36096
    ds_read_b64_tr_b16 v[78:79], v37 offset:37376
    s_waitcnt vmcnt(9)
    s_barrier
    s_waitcnt lgkmcnt(11)
    v_mfma_f32_32x32x16_bf16 v[128:143], v[40:43], a[24:27], v[128:143]
    ds_read_b128 a[8:11], v34 offset:0
    ds_read_b64_tr_b16 v[80:81], v36 offset:0
    ds_read_b64_tr_b16 v[82:83], v36 offset:1280
    v_mfma_f32_32x32x16_bf16 v[144:159], v[44:47], a[24:27], v[144:159]
    ds_read_b64_tr_b16 v[84:85], v36 offset:64
    ds_read_b64_tr_b16 v[86:87], v36 offset:1344
    v_mfma_f32_32x32x16_bf16 v[160:175], v[48:51], a[24:27], v[160:175]
    ds_read_b64_tr_b16 v[88:89], v36 offset:128
    ds_read_b64_tr_b16 v[90:91], v36 offset:1408
    v_mfma_f32_32x32x16_bf16 v[176:191], v[52:55], a[24:27], v[176:191]
    ds_read_b64_tr_b16 v[92:93], v36 offset:192
    ds_read_b64_tr_b16 v[94:95], v36 offset:1472
    v_mfma_f32_32x32x16_bf16 v[192:207], v[56:59], a[24:27], v[192:207]
    ds_read_b64_tr_b16 v[96:97], v36 offset:256
    ds_read_b64_tr_b16 v[98:99], v36 offset:1536
    s_waitcnt lgkmcnt(11)
    v_mfma_f32_32x32x16_bf16 v[128:143], v[60:63], a[28:31], v[128:143]
    ds_read_b128 a[12:15], v35 offset:0
    ds_read_b64_tr_b16 v[40:41], v36 offset:5120
    ds_read_b64_tr_b16 v[42:43], v36 offset:6400
    v_mfma_f32_32x32x16_bf16 v[144:159], v[64:67], a[28:31], v[144:159]
    ds_read_b64_tr_b16 v[44:45], v36 offset:5184
    ds_read_b64_tr_b16 v[46:47], v36 offset:6464
    v_mfma_f32_32x32x16_bf16 v[160:175], v[68:71], a[28:31], v[160:175]
    ds_read_b64_tr_b16 v[48:49], v36 offset:5248
    ds_read_b64_tr_b16 v[50:51], v36 offset:6528
    v_mfma_f32_32x32x16_bf16 v[176:191], v[72:75], a[28:31], v[176:191]
    ds_read_b64_tr_b16 v[52:53], v36 offset:5312
    ds_read_b64_tr_b16 v[54:55], v36 offset:6592
    v_mfma_f32_32x32x16_bf16 v[192:207], v[76:79], a[28:31], v[192:207]
    ds_read_b64_tr_b16 v[56:57], v36 offset:5376
    ds_read_b64_tr_b16 v[58:59], v36 offset:6656
    s_waitcnt vmcnt(5)
    s_waitcnt lgkmcnt(10)
    v_mfma_f32_32x32x16_bf16 v[128:143], v[80:83], a[0:3], v[128:143]
    ds_read_b128 a[16:19], v32 offset:4096
    ds_read_b64_tr_b16 v[60:61], v36 offset:10240
    ds_read_b64_tr_b16 v[62:63], v36 offset:11520
    v_mfma_f32_32x32x16_bf16 v[144:159], v[84:87], a[0:3], v[144:159]
    ds_read_b64_tr_b16 v[64:65], v36 offset:10304
    ds_read_b64_tr_b16 v[66:67], v36 offset:11584
    v_mfma_f32_32x32x16_bf16 v[160:175], v[88:91], a[0:3], v[160:175]
    ds_read_b64_tr_b16 v[68:69], v36 offset:10368
    ds_read_b64_tr_b16 v[70:71], v36 offset:11648
    v_mfma_f32_32x32x16_bf16 v[176:191], v[92:95], a[0:3], v[176:191]
    ds_read_b64_tr_b16 v[72:73], v36 offset:10432
    ds_read_b64_tr_b16 v[74:75], v36 offset:11712
    v_mfma_f32_32x32x16_bf16 v[192:207], v[96:99], a[0:3], v[192:207]
    ds_read_b64_tr_b16 v[76:77], v36 offset:10496
    ds_read_b64_tr_b16 v[78:79], v36 offset:11776
    s_waitcnt lgkmcnt(11)
    v_mfma_f32_32x32x16_bf16 v[128:143], v[40:43], a[4:7], v[128:143]
    ds_read_b128 a[20:23], v33 offset:4096
    ds_read_b64_tr_b16 v[80:81], v36 offset:15360
    ds_read_b64_tr_b16 v[82:83], v36 offset:16640
    v_mfma_f32_32x32x16_bf16 v[144:159], v[44:47], a[4:7], v[144:159]
    ds_read_b64_tr_b16 v[84:85], v36 offset:15424
    ds_read_b64_tr_b16 v[86:87], v36 offset:16704
    v_mfma_f32_32x32x16_bf16 v[160:175], v[48:51], a[4:7], v[160:175]
    ds_read_b64_tr_b16 v[88:89], v36 offset:15488
    ds_read_b64_tr_b16 v[90:91], v36 offset:16768
    v_mfma_f32_32x32x16_bf16 v[176:191], v[52:55], a[4:7], v[176:191]
    ds_read_b64_tr_b16 v[92:93], v36 offset:15552
    ds_read_b64_tr_b16 v[94:95], v36 offset:16832
    v_mfma_f32_32x32x16_bf16 v[192:207], v[56:59], a[4:7], v[192:207]
    ds_read_b64_tr_b16 v[96:97], v36 offset:15616
    ds_read_b64_tr_b16 v[98:99], v36 offset:16896
    s_waitcnt vmcnt(0)
    s_barrier
    s_waitcnt lgkmcnt(11)
    v_mfma_f32_32x32x16_bf16 v[128:143], v[60:63], a[8:11], v[128:143]
    ds_read_b128 a[24:27], v34 offset:4096
    ds_read_b64_tr_b16 v[40:41], v36 offset:20480
    ds_read_b64_tr_b16 v[42:43], v36 offset:21760
    v_mfma_f32_32x32x16_bf16 v[144:159], v[64:67], a[8:11], v[144:159]
    ds_read_b64_tr_b16 v[44:45], v36 offset:20544
    ds_read_b64_tr_b16 v[46:47], v36 offset:21824
    v_mfma_f32_32x32x16_bf16 v[160:175], v[68:71], a[8:11], v[160:175]
    ds_read_b64_tr_b16 v[48:49], v36 offset:20608
    ds_read_b64_tr_b16 v[50:51], v36 offset:21888
    v_mfma_f32_32x32x16_bf16 v[176:191], v[72:75], a[8:11], v[176:191]
    ds_read_b64_tr_b16 v[52:53], v36 offset:20672
    ds_read_b64_tr_b16 v[54:55], v36 offset:21952
    v_mfma_f32_32x32x16_bf16 v[192:207], v[76:79], a[8:11], v[192:207]
    ds_read_b64_tr_b16 v[56:57], v36 offset:20736
    ds_read_b64_tr_b16 v[58:59], v36 offset:22016
    s_waitcnt lgkmcnt(11)
    v_mfma_f32_32x32x16_bf16 v[128:143], v[80:83], a[12:15], v[128:143]
    ds_read_b128 a[28:31], v35 offset:4096
    ds_read_b64_tr_b16 v[60:61], v36 offset:25600
    ds_read_b64_tr_b16 v[62:63], v36 offset:26880
    v_mfma_f32_32x32x16_bf16 v[144:159], v[84:87], a[12:15], v[144:159]
    ds_read_b64_tr_b16 v[64:65], v36 offset:25664
    ds_read_b64_tr_b16 v[66:67], v36 offset:26944
    v_mfma_f32_32x32x16_bf16 v[160:175], v[88:91], a[12:15], v[160:175]
    ds_read_b64_tr_b16 v[68:69], v36 offset:25728
    ds_read_b64_tr_b16 v[70:71], v36 offset:27008
    v_mfma_f32_32x32x16_bf16 v[176:191], v[92:95], a[12:15], v[176:191]
    ds_read_b64_tr_b16 v[72:73], v36 offset:25792
    ds_read_b64_tr_b16 v[74:75], v36 offset:27072
    v_mfma_f32_32x32x16_bf16 v[192:207], v[96:99], a[12:15], v[192:207]
    ds_read_b64_tr_b16 v[76:77], v36 offset:25856
    ds_read_b64_tr_b16 v[78:79], v36 offset:27136
    s_waitcnt lgkmcnt(10)
    v_mfma_f32_32x32x16_bf16 v[128:143], v[40:43], a[16:19], v[128:143]
    ds_read_b64_tr_b16 v[80:81], v36 offset:30720
    ds_read_b64_tr_b16 v[82:83], v36 offset:32000
    v_mfma_f32_32x32x16_bf16 v[144:159], v[44:47], a[16:19], v[144:159]
    ds_read_b64_tr_b16 v[84:85], v36 offset:30784
    ds_read_b64_tr_b16 v[86:87], v36 offset:32064
    v_mfma_f32_32x32x16_bf16 v[160:175], v[48:51], a[16:19], v[160:175]
    ds_read_b64_tr_b16 v[88:89], v36 offset:30848
    ds_read_b64_tr_b16 v[90:91], v36 offset:32128
    v_mfma_f32_32x32x16_bf16 v[176:191], v[52:55], a[16:19], v[176:191]
    ds_read_b64_tr_b16 v[92:93], v36 offset:30912
    ds_read_b64_tr_b16 v[94:95], v36 offset:32192
    v_mfma_f32_32x32x16_bf16 v[192:207], v[56:59], a[16:19], v[192:207]
    ds_read_b64_tr_b16 v[96:97], v36 offset:30976
    ds_read_b64_tr_b16 v[98:99], v36 offset:32256
    ds_read_b64_tr_b16 v[40:41], v36 offset:35840
    ds_read_b64_tr_b16 v[42:43], v36 offset:37120
    ds_read_b64_tr_b16 v[44:45], v36 offset:35904
    ds_read_b64_tr_b16 v[46:47], v36 offset:37184
    ds_read_b64_tr_b16 v[48:49], v36 offset:35968
    ds_read_b64_tr_b16 v[50:51], v36 offset:37248
    ds_read_b64_tr_b16 v[52:53], v36 offset:36032
    ds_read_b64_tr_b16 v[54:55], v36 offset:37312
    ds_read_b64_tr_b16 v[56:57], v36 offset:36096
    ds_read_b64_tr_b16 v[58:59], v36 offset:37376
    s_waitcnt lgkmcnt(0)
    v_mfma_f32_32x32x16_bf16 v[128:143], v[60:63], a[20:23], v[128:143]
    v_mfma_f32_32x32x16_bf16 v[128:143], v[80:83], a[24:27], v[128:143]
    v_mfma_f32_32x32x16_bf16 v[128:143], v[40:43], a[28:31], v[128:143]
    v_mfma_f32_32x32x16_bf16 v[144:159], v[64:67], a[20:23], v[144:159]
    v_mfma_f32_32x32x16_bf16 v[144:159], v[84:87], a[24:27], v[144:159]
    v_mfma_f32_32x32x16_bf16 v[144:159], v[44:47], a[28:31], v[144:159]
    s_nop 8
    v_mfma_f32_32x32x16_bf16 v[160:175], v[68:71], a[20:23], v[160:175]
    v_cvt_pk_bf16_f32 v208, v128, v129
    v_cvt_pk_bf16_f32 v209, v130, v131
    v_cvt_pk_bf16_f32 v210, v132, v133
    v_cvt_pk_bf16_f32 v211, v134, v135
    v_cvt_pk_bf16_f32 v212, v136, v137
    v_mfma_f32_32x32x16_bf16 v[160:175], v[88:91], a[24:27], v[160:175]
    v_cvt_pk_bf16_f32 v213, v138, v139
    v_cvt_pk_bf16_f32 v214, v140, v141
    v_cvt_pk_bf16_f32 v215, v142, v143
    v_permlane32_swap_b32 v208, v210
    v_permlane32_swap_b32 v209, v211
    v_mfma_f32_32x32x16_bf16 v[160:175], v[48:51], a[28:31], v[160:175]
    s_nop 0
    v_permlane32_swap_b32 v212, v214
    v_permlane32_swap_b32 v213, v215
    buffer_store_dwordx4 v[208:211], v38, s[16:19], s40 offen offset:0 sc1
    buffer_store_dwordx4 v[212:215], v38, s[16:19], s40 offen offset:1024 sc1
    v_mfma_f32_32x32x16_bf16 v[176:191], v[72:75], a[20:23], v[176:191]
    v_cvt_pk_bf16_f32 v216, v144, v145
    v_cvt_pk_bf16_f32 v217, v146, v147
    v_cvt_pk_bf16_f32 v218, v148, v149
    v_cvt_pk_bf16_f32 v219, v150, v151
    v_cvt_pk_bf16_f32 v220, v152, v153
    v_mfma_f32_32x32x16_bf16 v[176:191], v[92:95], a[24:27], v[176:191]
    v_cvt_pk_bf16_f32 v221, v154, v155
    v_cvt_pk_bf16_f32 v222, v156, v157
    v_cvt_pk_bf16_f32 v223, v158, v159
    v_permlane32_swap_b32 v216, v218
    v_permlane32_swap_b32 v217, v219
    v_mfma_f32_32x32x16_bf16 v[176:191], v[52:55], a[28:31], v[176:191]
    s_nop 0
    v_permlane32_swap_b32 v220, v222
    v_permlane32_swap_b32 v221, v223
    buffer_store_dwordx4 v[216:219], v38, s[16:19], s41 offen offset:0 sc1
    buffer_store_dwordx4 v[220:223], v38, s[16:19], s41 offen offset:1024 sc1
    v_mfma_f32_32x32x16_bf16 v[192:207], v[76:79], a[20:23], v[192:207]
    v_cvt_pk_bf16_f32 v224, v160, v161
    v_cvt_pk_bf16_f32 v225, v162, v163
    v_cvt_pk_bf16_f32 v226, v164, v165
    v_cvt_pk_bf16_f32 v227, v166, v167
    v_cvt_pk_bf16_f32 v228, v168, v169
    v_mfma_f32_32x32x16_bf16 v[192:207], v[96:99], a[24:27], v[192:207]
    v_cvt_pk_bf16_f32 v229, v170, v171
    v_cvt_pk_bf16_f32 v230, v172, v173
    v_cvt_pk_bf16_f32 v231, v174, v175
    v_permlane32_swap_b32 v224, v226
    v_permlane32_swap_b32 v225, v227
    v_mfma_f32_32x32x16_bf16 v[192:207], v[56:59], a[28:31], v[192:207]
    s_nop 0
    v_permlane32_swap_b32 v228, v230
    v_permlane32_swap_b32 v229, v231
    buffer_store_dwordx4 v[224:227], v38, s[16:19], s42 offen offset:0 sc1
    buffer_store_dwordx4 v[228:231], v38, s[16:19], s42 offen offset:1024 sc1
    v_cvt_pk_bf16_f32 v232, v176, v177
    v_cvt_pk_bf16_f32 v233, v178, v179
    v_cvt_pk_bf16_f32 v234, v180, v181
    v_cvt_pk_bf16_f32 v235, v182, v183
    v_cvt_pk_bf16_f32 v236, v184, v185
    v_cvt_pk_bf16_f32 v237, v186, v187
    v_cvt_pk_bf16_f32 v238, v188, v189
    v_cvt_pk_bf16_f32 v239, v190, v191
    v_permlane32_swap_b32 v232, v234
    v_permlane32_swap_b32 v233, v235
    s_nop 0
    v_permlane32_swap_b32 v236, v238
    v_permlane32_swap_b32 v237, v239
    buffer_store_dwordx4 v[232:235], v38, s[16:19], s95 offen offset:0 sc1
    buffer_store_dwordx4 v[236:239], v38, s[16:19], s95 offen offset:1024 sc1
    v_cvt_pk_bf16_f32 v240, v192, v193
    v_cvt_pk_bf16_f32 v241, v194, v195
    v_cvt_pk_bf16_f32 v242, v196, v197
    v_cvt_pk_bf16_f32 v243, v198, v199
    v_cvt_pk_bf16_f32 v244, v200, v201
    v_cvt_pk_bf16_f32 v245, v202, v203
    v_cvt_pk_bf16_f32 v246, v204, v205
    v_cvt_pk_bf16_f32 v247, v206, v207
    v_permlane32_swap_b32 v240, v242
    v_permlane32_swap_b32 v241, v243
    s_nop 0
    v_permlane32_swap_b32 v244, v246
    v_permlane32_swap_b32 v245, v247
    buffer_store_dwordx4 v[240:243], v38, s[16:19], s96 offen offset:0 sc1
    buffer_store_dwordx4 v[244:247], v38, s[16:19], s96 offen offset:1024 sc1
    s_waitcnt vmcnt(0)
    s_barrier
    s_cmp_lg_u32 s3, 0
    s_cbranch_scc1 standalone__weight_only_int_quip__prompt_kernel_pub16
    v_mov_b32 v30, s38
    v_mov_b32 v31, s39
    s_mov_b64 exec, 0x7fff
    buffer_store_dwordx2 v[30:31], v28, s[32:35], 0 offen offset:0 sc1
    s_mov_b64 exec, -1
standalone__weight_only_int_quip__prompt_kernel_pub16:

    s_cmp_ge_u32 s5, 28
    s_cbranch_scc1 L_end
L_yonly:
    s_lshl_b32 s92, s62, 4
    s_add_u32 s92, s92, s63
    s_lshl_b32 s92, s92, 7
    s_add_u32 s92, s92, 65536
    v_and_b32 v29, 3, v2
    v_lshl_add_u32 v29, v29, 3, s92

    s_add_u32 s8, s60, 4538368
    s_addc_u32 s9, s61, 0
    s_mov_b32 s10, 2621440
    s_mov_b32 s11, 0x20000
    s_lshl_b32 s25, s63, 2
    s_add_u32 s25, s25, s3
    s_mul_i32 s25, s25, 40960
    v_lshlrev_b32 v20, 4, v2

    v_mov_b32 v26, v29
    s_lshl_b32 s92, s62, 4
    s_add_u32 s92, s92, s63
    s_lshl_b32 s92, s92, 8
    s_add_u32 s92, s92, 0
    s_cmp_eq_u32 s62, 13
    s_cselect_b32 s93, 14, 15
    v_min_u32 v29, 13, v2
    v_and_b32 v29, s93, v29
    v_lshl_add_u32 v29, v29, 3, s92
    s_add_u32 s92, s92, 128
    v_min_u32 v19, 11, v2
    v_and_b32 v19, s93, v19
    v_lshl_add_u32 v19, v19, 3, s92

    v_cmp_gt_u32 vcc, 32, v2
    s_nop 1
    v_cndmask_b32 v29, v26, v29, vcc
    s_mov_b32 s37, 0
standalone__weight_only_int_quip__prompt_kernel_pl18:
    buffer_load_dwordx2 v[8:9], v29, s[32:35], 0 offen sc1
    s_waitcnt vmcnt(0)
    v_cmp_ne_u64 vcc, s[38:39], v[8:9]
    s_cbranch_vccz standalone__weight_only_int_quip__prompt_kernel_wd17
    s_sleep 1

    s_add_u32 s37, s37, 1
    s_cmp_lt_u32 s37, 524288
    s_cbranch_scc1 standalone__weight_only_int_quip__prompt_kernel_pl18

standalone__weight_only_int_quip__prompt_kernel_wd17:
    buffer_load_dwordx4 v[128:131], v20, s[8:11], s25 offen offset:0 sc1
    buffer_load_dwordx4 v[132:135], v20, s[8:11], s25 offen offset:1024 sc1
    buffer_load_dwordx4 v[136:139], v20, s[8:11], s25 offen offset:2048 sc1
    buffer_load_dwordx4 v[140:143], v20, s[8:11], s25 offen offset:3072 sc1
    s_add_u32 s25, s25, 4096
    buffer_load_dwordx4 v[144:147], v20, s[8:11], s25 offen offset:0 sc1
    buffer_load_dwordx4 v[148:151], v20, s[8:11], s25 offen offset:1024 sc1
    buffer_load_dwordx4 v[152:155], v20, s[8:11], s25 offen offset:2048 sc1
    buffer_load_dwordx4 v[156:159], v20, s[8:11], s25 offen offset:3072 sc1
    s_add_u32 s25, s25, 4096
    buffer_load_dwordx4 v[160:163], v20, s[8:11], s25 offen offset:0 sc1
    buffer_load_dwordx4 v[164:167], v20, s[8:11], s25 offen offset:1024 sc1
    buffer_load_dwordx4 v[168:171], v20, s[8:11], s25 offen offset:2048 sc1
    buffer_load_dwordx4 v[172:175], v20, s[8:11], s25 offen offset:3072 sc1
    s_add_u32 s25, s25, 4096
    buffer_load_dwordx4 v[176:179], v20, s[8:11], s25 offen offset:0 sc1
    buffer_load_dwordx4 v[180:183], v20, s[8:11], s25 offen offset:1024 sc1
    buffer_load_dwordx4 v[184:187], v20, s[8:11], s25 offen offset:2048 sc1
    buffer_load_dwordx4 v[188:191], v20, s[8:11], s25 offen offset:3072 sc1
    s_add_u32 s25, s25, 4096
    s_barrier
L_y:
    s_add_u32 s12, s60, 2326528
    s_addc_u32 s13, s61, 0
    s_mov_b32 s14, 2211840
    s_mov_b32 s15, 0x20000
    s_mov_b32 s16, s56
    s_mov_b32 s17, s57
    s_mov_b32 s18, 7077888
    s_mov_b32 s19, 0x20000
    s_lshl_b32 s24, s62, 2
    s_add_u32 s24, s24, s3
    s_mul_i32 s24, s24, 40960
    s_mul_i32 s26, s3, 40960

    v_add_u32 v24, 0, v20
    v_add_u32 v25, 40960, v20
    v_add_u32 v26, 81920, v20
    v_add_u32 v27, 122880, v20
    v_and_b32 v3, 31, v2
    v_lshrrev_b32 v4, 5, v2
    v_and_b32 v5, 7, v2
    v_xor_b32 v4, v4, v5
    v_lshlrev_b32 v4, 4, v4
    v_lshl_add_u32 v16, v3, 7, v4
    v_add_u32 v16, s26, v16
    v_xor_b32 v21, 32, v16
    v_xor_b32 v22, 64, v16
    v_xor_b32 v23, 96, v16
    v_lshrrev_b32 v3, 3, v2
    v_xor_b32 v4, v3, v5
    v_lshlrev_b32 v4, 4, v4
    v_lshl_add_u32 v17, v3, 7, v4
    v_add_u32 v17, s26, v17
    v_mul_u32_u24 v18, 3456, v3
    v_lshl_add_u32 v18, v5, 4, v18
    s_lshl_b32 s28, s63, 2
    s_add_u32 s28, s28, s3
    s_mul_i32 s28, s28, 110592
    s_lshl_b32 s29, s62, 8
    s_add_u32 s28, s28, s29

    s_add_u32 m0, s26, 0
    s_nop 0
    buffer_load_dwordx4 v20, s[12:15], s24 offen offset:0 sc1 lds
    buffer_load_dwordx4 v20, s[12:15], s24 offen offset:1024 sc1 lds
    buffer_load_dwordx4 v20, s[12:15], s24 offen offset:2048 sc1 lds
    buffer_load_dwordx4 v20, s[12:15], s24 offen offset:3072 sc1 lds
    s_add_u32 s24, s24, 4096
    s_add_u32 m0, s26, 4096
    s_nop 0
    buffer_load_dwordx4 v20, s[12:15], s24 offen offset:0 sc1 lds
    buffer_load_dwordx4 v20, s[12:15], s24 offen offset:1024 sc1 lds
    buffer_load_dwordx4 v20, s[12:15], s24 offen offset:2048 sc1 lds
    buffer_load_dwordx4 v20, s[12:15], s24 offen offset:3072 sc1 lds
    s_add_u32 s24, s24, 4096
    s_add_u32 m0, s26, 8192
    s_nop 0
    buffer_load_dwordx4 v20, s[12:15], s24 offen offset:0 sc1 lds
    buffer_load_dwordx4 v20, s[12:15], s24 offen offset:1024 sc1 lds
    buffer_load_dwordx4 v20, s[12:15], s24 offen offset:2048 sc1 lds
    buffer_load_dwordx4 v20, s[12:15], s24 offen offset:3072 sc1 lds
    s_add_u32 s24, s24, 4096
    s_waitcnt vmcnt(8)
    s_barrier
    ds_read_b128 a[0:3], v24 offset:0
    ds_read_b128 a[4:7], v25 offset:0
    ds_read_b128 a[8:11], v26 offset:0
    ds_read_b128 a[12:15], v27 offset:0
    ds_read_b128 a[16:19], v24 offset:1024
    ds_read_b128 a[20:23], v25 offset:1024
    ds_read_b128 a[24:27], v26 offset:1024
    ds_read_b128 a[28:31], v27 offset:1024
    s_waitcnt lgkmcnt(4)
    v_mfma_f32_32x32x16_bf16 v[192:207], a[0:3], v[128:131], 0
    ds_read_b128 a[32:35], v24 offset:2048
    v_mfma_f32_32x32x16_bf16 v[208:223], a[4:7], v[128:131], 0
    ds_read_b128 a[36:39], v25 offset:2048
    s_add_u32 m0, s26, 12288
    s_nop 0
    buffer_load_dwordx4 v20, s[12:15], s24 offen offset:0 sc1 lds
    v_mfma_f32_32x32x16_bf16 v[224:239], a[8:11], v[128:131], 0
    ds_read_b128 a[40:43], v26 offset:2048
    v_mfma_f32_32x32x16_bf16 v[240:255], a[12:15], v[128:131], 0
    ds_read_b128 a[44:47], v27 offset:2048
    buffer_load_dwordx4 v20, s[12:15], s24 offen offset:1024 sc1 lds
    s_waitcnt lgkmcnt(4)
    v_mfma_f32_32x32x16_bf16 v[192:207], a[16:19], v[132:135], v[192:207]
    ds_read_b128 a[0:3], v24 offset:3072
    v_mfma_f32_32x32x16_bf16 v[208:223], a[20:23], v[132:135], v[208:223]
    ds_read_b128 a[4:7], v25 offset:3072
    buffer_load_dwordx4 v20, s[12:15], s24 offen offset:2048 sc1 lds
    v_mfma_f32_32x32x16_bf16 v[224:239], a[24:27], v[132:135], v[224:239]
    ds_read_b128 a[8:11], v26 offset:3072
    v_mfma_f32_32x32x16_bf16 v[240:255], a[28:31], v[132:135], v[240:255]
    ds_read_b128 a[12:15], v27 offset:3072
    buffer_load_dwordx4 v20, s[12:15], s24 offen offset:3072 sc1 lds
    s_add_u32 s24, s24, 4096
    s_waitcnt vmcnt(8)
    s_barrier
    s_waitcnt lgkmcnt(4)
    v_mfma_f32_32x32x16_bf16 v[192:207], a[32:35], v[136:139], v[192:207]
    ds_read_b128 a[16:19], v24 offset:4096
    v_mfma_f32_32x32x16_bf16 v[208:223], a[36:39], v[136:139], v[208:223]
    ds_read_b128 a[20:23], v25 offset:4096
    s_add_u32 m0, s26, 16384
    s_nop 0
    buffer_load_dwordx4 v20, s[12:15], s24 offen offset:0 sc1 lds
    v_mfma_f32_32x32x16_bf16 v[224:239], a[40:43], v[136:139], v[224:239]
    ds_read_b128 a[24:27], v26 offset:4096
    v_mfma_f32_32x32x16_bf16 v[240:255], a[44:47], v[136:139], v[240:255]
    ds_read_b128 a[28:31], v27 offset:4096
    buffer_load_dwordx4 v20, s[12:15], s24 offen offset:1024 sc1 lds
    s_waitcnt lgkmcnt(4)
    v_mfma_f32_32x32x16_bf16 v[192:207], a[0:3], v[140:143], v[192:207]
    ds_read_b128 a[32:35], v24 offset:5120
    v_mfma_f32_32x32x16_bf16 v[208:223], a[4:7], v[140:143], v[208:223]
    ds_read_b128 a[36:39], v25 offset:5120
    buffer_load_dwordx4 v20, s[12:15], s24 offen offset:2048 sc1 lds
    v_mfma_f32_32x32x16_bf16 v[224:239], a[8:11], v[140:143], v[224:239]
    ds_read_b128 a[40:43], v26 offset:5120
    v_mfma_f32_32x32x16_bf16 v[240:255], a[12:15], v[140:143], v[240:255]
    ds_read_b128 a[44:47], v27 offset:5120
    buffer_load_dwordx4 v20, s[12:15], s24 offen offset:3072 sc1 lds
    s_add_u32 s24, s24, 4096
    s_waitcnt lgkmcnt(4)
    v_mfma_f32_32x32x16_bf16 v[192:207], a[16:19], v[144:147], v[192:207]
    ds_read_b128 a[0:3], v24 offset:6144
    v_mfma_f32_32x32x16_bf16 v[208:223], a[20:23], v[144:147], v[208:223]
    ds_read_b128 a[4:7], v25 offset:6144
    buffer_load_dwordx4 v[64:67], v20, s[8:11], s25 offen offset:0 sc1
    v_mfma_f32_32x32x16_bf16 v[224:239], a[24:27], v[144:147], v[224:239]
    ds_read_b128 a[8:11], v26 offset:6144
    v_mfma_f32_32x32x16_bf16 v[240:255], a[28:31], v[144:147], v[240:255]
    ds_read_b128 a[12:15], v27 offset:6144
    buffer_load_dwordx4 v[68:71], v20, s[8:11], s25 offen offset:1024 sc1
    s_waitcnt lgkmcnt(4)
    v_mfma_f32_32x32x16_bf16 v[192:207], a[32:35], v[148:151], v[192:207]
    ds_read_b128 a[16:19], v24 offset:7168
    v_mfma_f32_32x32x16_bf16 v[208:223], a[36:39], v[148:151], v[208:223]
    ds_read_b128 a[20:23], v25 offset:7168
    buffer_load_dwordx4 v[72:75], v20, s[8:11], s25 offen offset:2048 sc1
    v_mfma_f32_32x32x16_bf16 v[224:239], a[40:43], v[148:151], v[224:239]
    ds_read_b128 a[24:27], v26 offset:7168
    v_mfma_f32_32x32x16_bf16 v[240:255], a[44:47], v[148:151], v[240:255]
    ds_read_b128 a[28:31], v27 offset:7168
    buffer_load_dwordx4 v[76:79], v20, s[8:11], s25 offen offset:3072 sc1
    s_add_u32 s25, s25, 4096
    s_waitcnt vmcnt(12)
    s_barrier
    s_waitcnt lgkmcnt(4)
    v_mfma_f32_32x32x16_bf16 v[192:207], a[0:3], v[152:155], v[192:207]
    ds_read_b128 a[32:35], v24 offset:8192
    v_mfma_f32_32x32x16_bf16 v[208:223], a[4:7], v[152:155], v[208:223]
    ds_read_b128 a[36:39], v25 offset:8192
    s_add_u32 m0, s26, 20480
    s_nop 0
    buffer_load_dwordx4 v20, s[12:15], s24 offen offset:0 sc1 lds
    v_mfma_f32_32x32x16_bf16 v[224:239], a[8:11], v[152:155], v[224:239]
    ds_read_b128 a[40:43], v26 offset:8192
    v_mfma_f32_32x32x16_bf16 v[240:255], a[12:15], v[152:155], v[240:255]
    ds_read_b128 a[44:47], v27 offset:8192
    buffer_load_dwordx4 v20, s[12:15], s24 offen offset:1024 sc1 lds
    s_waitcnt lgkmcnt(4)
    v_mfma_f32_32x32x16_bf16 v[192:207], a[16:19], v[156:159], v[192:207]
    ds_read_b128 a[0:3], v24 offset:9216
    v_mfma_f32_32x32x16_bf16 v[208:223], a[20:23], v[156:159], v[208:223]
    ds_read_b128 a[4:7], v25 offset:9216
    buffer_load_dwordx4 v20, s[12:15], s24 offen offset:2048 sc1 lds
    v_mfma_f32_32x32x16_bf16 v[224:239], a[24:27], v[156:159], v[224:239]
    ds_read_b128 a[8:11], v26 offset:9216
    v_mfma_f32_32x32x16_bf16 v[240:255], a[28:31], v[156:159], v[240:255]
    ds_read_b128 a[12:15], v27 offset:9216
    buffer_load_dwordx4 v20, s[12:15], s24 offen offset:3072 sc1 lds
    s_add_u32 s24, s24, 4096
    s_waitcnt lgkmcnt(4)
    v_mfma_f32_32x32x16_bf16 v[192:207], a[32:35], v[160:163], v[192:207]
    ds_read_b128 a[16:19], v24 offset:10240
    v_mfma_f32_32x32x16_bf16 v[208:223], a[36:39], v[160:163], v[208:223]
    ds_read_b128 a[20:23], v25 offset:10240
    buffer_load_dwordx4 v[80:83], v20, s[8:11], s25 offen offset:0 sc1
    v_mfma_f32_32x32x16_bf16 v[224:239], a[40:43], v[160:163], v[224:239]
    ds_read_b128 a[24:27], v26 offset:10240
    v_mfma_f32_32x32x16_bf16 v[240:255], a[44:47], v[160:163], v[240:255]
    ds_read_b128 a[28:31], v27 offset:10240
    buffer_load_dwordx4 v[84:87], v20, s[8:11], s25 offen offset:1024 sc1
    s_waitcnt lgkmcnt(4)
    v_mfma_f32_32x32x16_bf16 v[192:207], a[0:3], v[164:167], v[192:207]
    ds_read_b128 a[32:35], v24 offset:11264
    v_mfma_f32_32x32x16_bf16 v[208:223], a[4:7], v[164:167], v[208:223]
    ds_read_b128 a[36:39], v25 offset:11264
    buffer_load_dwordx4 v[88:91], v20, s[8:11], s25 offen offset:2048 sc1
    v_mfma_f32_32x32x16_bf16 v[224:239], a[8:11], v[164:167], v[224:239]
    ds_read_b128 a[40:43], v26 offset:11264
    v_mfma_f32_32x32x16_bf16 v[240:255], a[12:15], v[164:167], v[240:255]
    ds_read_b128 a[44:47], v27 offset:11264
    buffer_load_dwordx4 v[92:95], v20, s[8:11], s25 offen offset:3072 sc1
    s_add_u32 s25, s25, 4096
    s_waitcnt vmcnt(16)
    s_barrier
    s_waitcnt lgkmcnt(4)
    v_mfma_f32_32x32x16_bf16 v[192:207], a[16:19], v[168:171], v[192:207]
    ds_read_b128 a[0:3], v24 offset:12288
    v_mfma_f32_32x32x16_bf16 v[208:223], a[20:23], v[168:171], v[208:223]
    ds_read_b128 a[4:7], v25 offset:12288
    s_add_u32 m0, s26, 24576
    s_nop 0
    buffer_load_dwordx4 v20, s[12:15], s24 offen offset:0 sc1 lds
    v_mfma_f32_32x32x16_bf16 v[224:239], a[24:27], v[168:171], v[224:239]
    ds_read_b128 a[8:11], v26 offset:12288
    v_mfma_f32_32x32x16_bf16 v[240:255], a[28:31], v[168:171], v[240:255]
    ds_read_b128 a[12:15], v27 offset:12288
    buffer_load_dwordx4 v20, s[12:15], s24 offen offset:1024 sc1 lds
    s_waitcnt lgkmcnt(4)
    v_mfma_f32_32x32x16_bf16 v[192:207], a[32:35], v[172:175], v[192:207]
    ds_read_b128 a[16:19], v24 offset:13312
    v_mfma_f32_32x32x16_bf16 v[208:223], a[36:39], v[172:175], v[208:223]
    ds_read_b128 a[20:23], v25 offset:13312
    buffer_load_dwordx4 v20, s[12:15], s24 offen offset:2048 sc1 lds
    v_mfma_f32_32x32x16_bf16 v[224:239], a[40:43], v[172:175], v[224:239]
    ds_read_b128 a[24:27], v26 offset:13312
    v_mfma_f32_32x32x16_bf16 v[240:255], a[44:47], v[172:175], v[240:255]
    ds_read_b128 a[28:31], v27 offset:13312
    buffer_load_dwordx4 v20, s[12:15], s24 offen offset:3072 sc1 lds
    s_add_u32 s24, s24, 4096
    buffer_load_dwordx2 v[30:31], v19, s[32:35], 0 offen sc1
    s_waitcnt lgkmcnt(4)
    v_mfma_f32_32x32x16_bf16 v[192:207], a[0:3], v[176:179], v[192:207]
    ds_read_b128 a[32:35], v24 offset:14336
    v_mfma_f32_32x32x16_bf16 v[208:223], a[4:7], v[176:179], v[208:223]
    ds_read_b128 a[36:39], v25 offset:14336
    buffer_load_dwordx4 v[96:99], v20, s[8:11], s25 offen offset:0 sc1
    v_mfma_f32_32x32x16_bf16 v[224:239], a[8:11], v[176:179], v[224:239]
    ds_read_b128 a[40:43], v26 offset:14336
    v_mfma_f32_32x32x16_bf16 v[240:255], a[12:15], v[176:179], v[240:255]
    ds_read_b128 a[44:47], v27 offset:14336
    buffer_load_dwordx4 v[100:103], v20, s[8:11], s25 offen offset:1024 sc1
    s_waitcnt lgkmcnt(4)
    v_mfma_f32_32x32x16_bf16 v[192:207], a[16:19], v[180:183], v[192:207]
    ds_read_b128 a[0:3], v24 offset:15360
    v_mfma_f32_32x32x16_bf16 v[208:223], a[20:23], v[180:183], v[208:223]
    ds_read_b128 a[4:7], v25 offset:15360
    buffer_load_dwordx4 v[104:107], v20, s[8:11], s25 offen offset:2048 sc1
    v_mfma_f32_32x32x16_bf16 v[224:239], a[24:27], v[180:183], v[224:239]
    ds_read_b128 a[8:11], v26 offset:15360
    v_mfma_f32_32x32x16_bf16 v[240:255], a[28:31], v[180:183], v[240:255]
    ds_read_b128 a[12:15], v27 offset:15360
    buffer_load_dwordx4 v[108:111], v20, s[8:11], s25 offen offset:3072 sc1
    s_add_u32 s25, s25, 4096
    s_waitcnt vmcnt(13)
    s_barrier
    s_waitcnt lgkmcnt(4)
    v_mfma_f32_32x32x16_bf16 v[192:207], a[32:35], v[184:187], v[192:207]
    ds_read_b128 a[16:19], v24 offset:16384
    v_mfma_f32_32x32x16_bf16 v[208:223], a[36:39], v[184:187], v[208:223]
    ds_read_b128 a[20:23], v25 offset:16384
    buffer_load_dwordx4 v[112:115], v20, s[8:11], s25 offen offset:0 sc1
    v_mfma_f32_32x32x16_bf16 v[224:239], a[40:43], v[184:187], v[224:239]
    ds_read_b128 a[24:27], v26 offset:16384
    v_mfma_f32_32x32x16_bf16 v[240:255], a[44:47], v[184:187], v[240:255]
    ds_read_b128 a[28:31], v27 offset:16384
    buffer_load_dwordx4 v[116:119], v20, s[8:11], s25 offen offset:1024 sc1
    s_waitcnt lgkmcnt(4)
    v_mfma_f32_32x32x16_bf16 v[192:207], a[0:3], v[188:191], v[192:207]
    ds_read_b128 a[32:35], v24 offset:17408
    v_mfma_f32_32x32x16_bf16 v[208:223], a[4:7], v[188:191], v[208:223]
    ds_read_b128 a[36:39], v25 offset:17408
    buffer_load_dwordx4 v[120:123], v20, s[8:11], s25 offen offset:2048 sc1
    v_mfma_f32_32x32x16_bf16 v[224:239], a[8:11], v[188:191], v[224:239]
    ds_read_b128 a[40:43], v26 offset:17408
    v_mfma_f32_32x32x16_bf16 v[240:255], a[12:15], v[188:191], v[240:255]
    ds_read_b128 a[44:47], v27 offset:17408
    buffer_load_dwordx4 v[124:127], v20, s[8:11], s25 offen offset:3072 sc1
    s_add_u32 s25, s25, 4096
    s_waitcnt vmcnt(8)
    v_cmp_ne_u64 vcc, s[38:39], v[30:31]
    s_cbranch_vccz standalone__weight_only_int_quip__prompt_kernel_f2ok19
    v_mov_b32 v29, v19
    s_mov_b32 s37, 0
standalone__weight_only_int_quip__prompt_kernel_pl21:
    buffer_load_dwordx2 v[8:9], v29, s[32:35], 0 offen sc1
    s_waitcnt vmcnt(0)
    v_cmp_ne_u64 vcc, s[38:39], v[8:9]
    s_cbranch_vccz standalone__weight_only_int_quip__prompt_kernel_wd20
    s_sleep 1

    s_add_u32 s37, s37, 1
    s_cmp_lt_u32 s37, 524288
    s_cbranch_scc1 standalone__weight_only_int_quip__prompt_kernel_pl21

standalone__weight_only_int_quip__prompt_kernel_wd20:
standalone__weight_only_int_quip__prompt_kernel_f2ok19:
    s_waitcnt lgkmcnt(4)
    v_mfma_f32_32x32x16_bf16 v[192:207], a[16:19], v[64:67], v[192:207]
    ds_read_b128 a[0:3], v24 offset:18432
    v_mfma_f32_32x32x16_bf16 v[208:223], a[20:23], v[64:67], v[208:223]
    ds_read_b128 a[4:7], v25 offset:18432
    s_add_u32 m0, s26, 28672
    s_nop 0
    buffer_load_dwordx4 v20, s[12:15], s24 offen offset:0 sc1 lds
    v_mfma_f32_32x32x16_bf16 v[224:239], a[24:27], v[64:67], v[224:239]
    ds_read_b128 a[8:11], v26 offset:18432
    v_mfma_f32_32x32x16_bf16 v[240:255], a[28:31], v[64:67], v[240:255]
    ds_read_b128 a[12:15], v27 offset:18432
    buffer_load_dwordx4 v20, s[12:15], s24 offen offset:1024 sc1 lds
    s_waitcnt lgkmcnt(4)
    v_mfma_f32_32x32x16_bf16 v[192:207], a[32:35], v[68:71], v[192:207]
    ds_read_b128 a[16:19], v24 offset:19456
    v_mfma_f32_32x32x16_bf16 v[208:223], a[36:39], v[68:71], v[208:223]
    ds_read_b128 a[20:23], v25 offset:19456
    buffer_load_dwordx4 v20, s[12:15], s24 offen offset:2048 sc1 lds
    v_mfma_f32_32x32x16_bf16 v[224:239], a[40:43], v[68:71], v[224:239]
    ds_read_b128 a[24:27], v26 offset:19456
    v_mfma_f32_32x32x16_bf16 v[240:255], a[44:47], v[68:71], v[240:255]
    ds_read_b128 a[28:31], v27 offset:19456
    buffer_load_dwordx4 v20, s[12:15], s24 offen offset:3072 sc1 lds
    s_add_u32 s24, s24, 4096
    s_waitcnt lgkmcnt(4)
    v_mfma_f32_32x32x16_bf16 v[192:207], a[0:3], v[72:75], v[192:207]
    ds_read_b128 a[32:35], v24 offset:20480
    v_mfma_f32_32x32x16_bf16 v[208:223], a[4:7], v[72:75], v[208:223]
    ds_read_b128 a[36:39], v25 offset:20480
    s_add_u32 m0, s26, 32768
    s_nop 0
    buffer_load_dwordx4 v20, s[12:15], s24 offen offset:0 sc1 lds
    v_mfma_f32_32x32x16_bf16 v[224:239], a[8:11], v[72:75], v[224:239]
    ds_read_b128 a[40:43], v26 offset:20480
    v_mfma_f32_32x32x16_bf16 v[240:255], a[12:15], v[72:75], v[240:255]
    ds_read_b128 a[44:47], v27 offset:20480
    buffer_load_dwordx4 v20, s[12:15], s24 offen offset:1024 sc1 lds
    s_waitcnt lgkmcnt(4)
    v_mfma_f32_32x32x16_bf16 v[192:207], a[16:19], v[76:79], v[192:207]
    ds_read_b128 a[0:3], v24 offset:21504
    v_mfma_f32_32x32x16_bf16 v[208:223], a[20:23], v[76:79], v[208:223]
    ds_read_b128 a[4:7], v25 offset:21504
    buffer_load_dwordx4 v20, s[12:15], s24 offen offset:2048 sc1 lds
    v_mfma_f32_32x32x16_bf16 v[224:239], a[24:27], v[76:79], v[224:239]
    ds_read_b128 a[8:11], v26 offset:21504
    v_mfma_f32_32x32x16_bf16 v[240:255], a[28:31], v[76:79], v[240:255]
    ds_read_b128 a[12:15], v27 offset:21504
    buffer_load_dwordx4 v20, s[12:15], s24 offen offset:3072 sc1 lds
    s_add_u32 s24, s24, 4096
    s_waitcnt lgkmcnt(4)
    v_mfma_f32_32x32x16_bf16 v[192:207], a[32:35], v[80:83], v[192:207]
    ds_read_b128 a[16:19], v24 offset:22528
    v_mfma_f32_32x32x16_bf16 v[208:223], a[36:39], v[80:83], v[208:223]
    ds_read_b128 a[20:23], v25 offset:22528
    s_add_u32 m0, s26, 36864
    s_nop 0
    buffer_load_dwordx4 v20, s[12:15], s24 offen offset:0 sc1 lds
    v_mfma_f32_32x32x16_bf16 v[224:239], a[40:43], v[80:83], v[224:239]
    ds_read_b128 a[24:27], v26 offset:22528
    v_mfma_f32_32x32x16_bf16 v[240:255], a[44:47], v[80:83], v[240:255]
    ds_read_b128 a[28:31], v27 offset:22528
    buffer_load_dwordx4 v20, s[12:15], s24 offen offset:1024 sc1 lds
    s_waitcnt lgkmcnt(4)
    v_mfma_f32_32x32x16_bf16 v[192:207], a[0:3], v[84:87], v[192:207]
    ds_read_b128 a[32:35], v24 offset:23552
    v_mfma_f32_32x32x16_bf16 v[208:223], a[4:7], v[84:87], v[208:223]
    ds_read_b128 a[36:39], v25 offset:23552
    buffer_load_dwordx4 v20, s[12:15], s24 offen offset:2048 sc1 lds
    v_mfma_f32_32x32x16_bf16 v[224:239], a[8:11], v[84:87], v[224:239]
    ds_read_b128 a[40:43], v26 offset:23552
    v_mfma_f32_32x32x16_bf16 v[240:255], a[12:15], v[84:87], v[240:255]
    ds_read_b128 a[44:47], v27 offset:23552
    buffer_load_dwordx4 v20, s[12:15], s24 offen offset:3072 sc1 lds
    s_add_u32 s24, s24, 4096
    s_barrier
    s_waitcnt lgkmcnt(4)
    v_mfma_f32_32x32x16_bf16 v[192:207], a[16:19], v[88:91], v[192:207]
    ds_read_b128 a[0:3], v24 offset:24576
    v_mfma_f32_32x32x16_bf16 v[208:223], a[20:23], v[88:91], v[208:223]
    ds_read_b128 a[4:7], v25 offset:24576
    buffer_load_dwordx4 a[144:147], v20, s[8:11], s25 offen offset:0 sc1
    v_mfma_f32_32x32x16_bf16 v[224:239], a[24:27], v[88:91], v[224:239]
    ds_read_b128 a[8:11], v26 offset:24576
    v_mfma_f32_32x32x16_bf16 v[240:255], a[28:31], v[88:91], v[240:255]
    ds_read_b128 a[12:15], v27 offset:24576
    buffer_load_dwordx4 a[148:151], v20, s[8:11], s25 offen offset:1024 sc1
    s_waitcnt lgkmcnt(4)
    v_mfma_f32_32x32x16_bf16 v[192:207], a[32:35], v[92:95], v[192:207]
    ds_read_b128 a[16:19], v24 offset:25600
    v_mfma_f32_32x32x16_bf16 v[208:223], a[36:39], v[92:95], v[208:223]
    ds_read_b128 a[20:23], v25 offset:25600
    buffer_load_dwordx4 a[152:155], v20, s[8:11], s25 offen offset:2048 sc1
    v_mfma_f32_32x32x16_bf16 v[224:239], a[40:43], v[92:95], v[224:239]
    ds_read_b128 a[24:27], v26 offset:25600
    v_mfma_f32_32x32x16_bf16 v[240:255], a[44:47], v[92:95], v[240:255]
    ds_read_b128 a[28:31], v27 offset:25600
    buffer_load_dwordx4 a[156:159], v20, s[8:11], s25 offen offset:3072 sc1
    s_add_u32 s25, s25, 4096
    s_waitcnt vmcnt(20)
    s_waitcnt lgkmcnt(4)
    v_mfma_f32_32x32x16_bf16 v[192:207], a[0:3], v[96:99], v[192:207]
    ds_read_b128 a[32:35], v24 offset:26624
    v_mfma_f32_32x32x16_bf16 v[208:223], a[4:7], v[96:99], v[208:223]
    ds_read_b128 a[36:39], v25 offset:26624
    buffer_load_dwordx4 a[160:163], v20, s[8:11], s25 offen offset:0 sc1
    v_mfma_f32_32x32x16_bf16 v[224:239], a[8:11], v[96:99], v[224:239]
    ds_read_b128 a[40:43], v26 offset:26624
    v_mfma_f32_32x32x16_bf16 v[240:255], a[12:15], v[96:99], v[240:255]
    ds_read_b128 a[44:47], v27 offset:26624
    buffer_load_dwordx4 a[164:167], v20, s[8:11], s25 offen offset:1024 sc1
    s_waitcnt lgkmcnt(4)
    v_mfma_f32_32x32x16_bf16 v[192:207], a[16:19], v[100:103], v[192:207]
    ds_read_b128 a[0:3], v24 offset:27648
    v_mfma_f32_32x32x16_bf16 v[208:223], a[20:23], v[100:103], v[208:223]
    ds_read_b128 a[4:7], v25 offset:27648
    buffer_load_dwordx4 a[168:171], v20, s[8:11], s25 offen offset:2048 sc1
    v_mfma_f32_32x32x16_bf16 v[224:239], a[24:27], v[100:103], v[224:239]
    ds_read_b128 a[8:11], v26 offset:27648
    v_mfma_f32_32x32x16_bf16 v[240:255], a[28:31], v[100:103], v[240:255]
    ds_read_b128 a[12:15], v27 offset:27648
    buffer_load_dwordx4 a[172:175], v20, s[8:11], s25 offen offset:3072 sc1
    s_add_u32 s25, s25, 4096
    s_waitcnt vmcnt(16)
    s_barrier
    s_waitcnt lgkmcnt(4)
    v_mfma_f32_32x32x16_bf16 v[192:207], a[32:35], v[104:107], v[192:207]
    ds_read_b128 a[16:19], v24 offset:28672
    v_mfma_f32_32x32x16_bf16 v[208:223], a[36:39], v[104:107], v[208:223]
    ds_read_b128 a[20:23], v25 offset:28672
    v_mfma_f32_32x32x16_bf16 v[224:239], a[40:43], v[104:107], v[224:239]
    ds_read_b128 a[24:27], v26 offset:28672
    v_mfma_f32_32x32x16_bf16 v[240:255], a[44:47], v[104:107], v[240:255]
    ds_read_b128 a[28:31], v27 offset:28672
    s_waitcnt lgkmcnt(4)
    v_mfma_f32_32x32x16_bf16 v[192:207], a[0:3], v[108:111], v[192:207]
    ds_read_b128 a[32:35], v24 offset:29696
    v_mfma_f32_32x32x16_bf16 v[208:223], a[4:7], v[108:111], v[208:223]
    ds_read_b128 a[36:39], v25 offset:29696
    v_mfma_f32_32x32x16_bf16 v[224:239], a[8:11], v[108:111], v[224:239]
    ds_read_b128 a[40:43], v26 offset:29696
    v_mfma_f32_32x32x16_bf16 v[240:255], a[12:15], v[108:111], v[240:255]
    ds_read_b128 a[44:47], v27 offset:29696
    s_waitcnt lgkmcnt(4)
    v_mfma_f32_32x32x16_bf16 v[192:207], a[16:19], v[112:115], v[192:207]
    ds_read_b128 a[0:3], v24 offset:30720
    v_mfma_f32_32x32x16_bf16 v[208:223], a[20:23], v[112:115], v[208:223]
    ds_read_b128 a[4:7], v25 offset:30720
    v_mfma_f32_32x32x16_bf16 v[224:239], a[24:27], v[112:115], v[224:239]
    ds_read_b128 a[8:11], v26 offset:30720
    v_mfma_f32_32x32x16_bf16 v[240:255], a[28:31], v[112:115], v[240:255]
    ds_read_b128 a[12:15], v27 offset:30720
    s_waitcnt lgkmcnt(4)
    v_mfma_f32_32x32x16_bf16 v[192:207], a[32:35], v[116:119], v[192:207]
    ds_read_b128 a[16:19], v24 offset:31744
    v_mfma_f32_32x32x16_bf16 v[208:223], a[36:39], v[116:119], v[208:223]
    ds_read_b128 a[20:23], v25 offset:31744
    v_mfma_f32_32x32x16_bf16 v[224:239], a[40:43], v[116:119], v[224:239]
    ds_read_b128 a[24:27], v26 offset:31744
    v_mfma_f32_32x32x16_bf16 v[240:255], a[44:47], v[116:119], v[240:255]
    ds_read_b128 a[28:31], v27 offset:31744
    s_waitcnt vmcnt(8)
    s_barrier
    s_waitcnt lgkmcnt(4)
    v_mfma_f32_32x32x16_bf16 v[192:207], a[0:3], v[120:123], v[192:207]
    ds_read_b128 a[32:35], v24 offset:32768
    v_mfma_f32_32x32x16_bf16 v[208:223], a[4:7], v[120:123], v[208:223]
    ds_read_b128 a[36:39], v25 offset:32768
    v_mfma_f32_32x32x16_bf16 v[224:239], a[8:11], v[120:123], v[224:239]
    ds_read_b128 a[40:43], v26 offset:32768
    v_mfma_f32_32x32x16_bf16 v[240:255], a[12:15], v[120:123], v[240:255]
    ds_read_b128 a[44:47], v27 offset:32768
    s_waitcnt lgkmcnt(4)
    v_mfma_f32_32x32x16_bf16 v[192:207], a[16:19], v[124:127], v[192:207]
    ds_read_b128 a[0:3], v24 offset:33792
    v_mfma_f32_32x32x16_bf16 v[208:223], a[20:23], v[124:127], v[208:223]
    ds_read_b128 a[4:7], v25 offset:33792
    v_mfma_f32_32x32x16_bf16 v[224:239], a[24:27], v[124:127], v[224:239]
    ds_read_b128 a[8:11], v26 offset:33792
    v_mfma_f32_32x32x16_bf16 v[240:255], a[28:31], v[124:127], v[240:255]
    ds_read_b128 a[12:15], v27 offset:33792
    s_waitcnt vmcnt(4)
    s_waitcnt lgkmcnt(4)
    v_mfma_f32_32x32x16_bf16 v[192:207], a[32:35], a[144:147], v[192:207]
    ds_read_b128 a[16:19], v24 offset:34816
    v_mfma_f32_32x32x16_bf16 v[208:223], a[36:39], a[144:147], v[208:223]
    ds_read_b128 a[20:23], v25 offset:34816
    v_mfma_f32_32x32x16_bf16 v[224:239], a[40:43], a[144:147], v[224:239]
    ds_read_b128 a[24:27], v26 offset:34816
    v_mfma_f32_32x32x16_bf16 v[240:255], a[44:47], a[144:147], v[240:255]
    ds_read_b128 a[28:31], v27 offset:34816
    s_waitcnt lgkmcnt(4)
    v_mfma_f32_32x32x16_bf16 v[192:207], a[0:3], a[148:151], v[192:207]
    ds_read_b128 a[32:35], v24 offset:35840
    v_mfma_f32_32x32x16_bf16 v[208:223], a[4:7], a[148:151], v[208:223]
    ds_read_b128 a[36:39], v25 offset:35840
    v_mfma_f32_32x32x16_bf16 v[224:239], a[8:11], a[148:151], v[224:239]
    ds_read_b128 a[40:43], v26 offset:35840
    v_mfma_f32_32x32x16_bf16 v[240:255], a[12:15], a[148:151], v[240:255]
    ds_read_b128 a[44:47], v27 offset:35840
    s_waitcnt lgkmcnt(4)
    v_mfma_f32_32x32x16_bf16 v[192:207], a[16:19], a[152:155], v[192:207]
    ds_read_b128 a[48:51], v24 offset:36864
    v_mfma_f32_32x32x16_bf16 v[208:223], a[20:23], a[152:155], v[208:223]
    ds_read_b128 a[52:55], v24 offset:37888
    v_mfma_f32_32x32x16_bf16 v[224:239], a[24:27], a[152:155], v[224:239]
    ds_read_b128 a[56:59], v24 offset:38912
    v_mfma_f32_32x32x16_bf16 v[240:255], a[28:31], a[152:155], v[240:255]
    ds_read_b128 a[60:63], v24 offset:39936
    s_waitcnt lgkmcnt(4)
    v_mfma_f32_32x32x16_bf16 v[192:207], a[32:35], a[156:159], v[192:207]
    ds_read_b128 a[64:67], v25 offset:36864
    v_mfma_f32_32x32x16_bf16 v[208:223], a[36:39], a[156:159], v[208:223]
    ds_read_b128 a[68:71], v25 offset:37888
    v_mfma_f32_32x32x16_bf16 v[224:239], a[40:43], a[156:159], v[224:239]
    ds_read_b128 a[72:75], v25 offset:38912
    v_mfma_f32_32x32x16_bf16 v[240:255], a[44:47], a[156:159], v[240:255]
    ds_read_b128 a[76:79], v25 offset:39936
    s_waitcnt vmcnt(0)
    s_add_u32 s29, s28, 27648
    s_add_u32 s30, s28, 55296
    s_add_u32 s31, s28, 82944
    s_waitcnt lgkmcnt(4)
    v_mfma_f32_32x32x16_bf16 v[192:207], a[48:51], a[160:163], v[192:207]
    ds_read_b128 a[80:83], v26 offset:36864
    v_mfma_f32_32x32x16_bf16 v[192:207], a[52:55], a[164:167], v[192:207]
    ds_read_b128 a[84:87], v26 offset:37888
    v_mfma_f32_32x32x16_bf16 v[192:207], a[56:59], a[168:171], v[192:207]
    ds_read_b128 a[88:91], v26 offset:38912
    v_mfma_f32_32x32x16_bf16 v[192:207], a[60:63], a[172:175], v[192:207]
    ds_read_b128 a[92:95], v26 offset:39936
    s_waitcnt lgkmcnt(4)
    v_mfma_f32_32x32x16_bf16 v[208:223], a[64:67], a[160:163], v[208:223]
    ds_read_b128 a[96:99], v27 offset:36864
    ds_read_b128 a[100:103], v27 offset:37888
    v_mfma_f32_32x32x16_bf16 v[208:223], a[68:71], a[164:167], v[208:223]
    ds_read_b128 a[104:107], v27 offset:38912
    ds_read_b128 a[108:111], v27 offset:39936
    v_mfma_f32_32x32x16_bf16 v[208:223], a[72:75], a[168:171], v[208:223]
    s_nop 4
    v_cvt_pk_bf16_f32 v32, v192, v193
    v_cvt_pk_bf16_f32 v33, v194, v195
    v_cvt_pk_bf16_f32 v34, v196, v197
    v_cvt_pk_bf16_f32 v35, v198, v199
    v_cvt_pk_bf16_f32 v36, v200, v201
    v_mfma_f32_32x32x16_bf16 v[208:223], a[76:79], a[172:175], v[208:223]
    v_cvt_pk_bf16_f32 v37, v202, v203
    v_cvt_pk_bf16_f32 v38, v204, v205
    v_cvt_pk_bf16_f32 v39, v206, v207
    v_permlane32_swap_b32 v32, v34
    v_permlane32_swap_b32 v33, v35
    s_waitcnt lgkmcnt(4)
    v_mfma_f32_32x32x16_bf16 v[224:239], a[80:83], a[160:163], v[224:239]
    s_nop 0
    v_permlane32_swap_b32 v36, v38
    v_permlane32_swap_b32 v37, v39
    ds_write_b128 v16, v[32:35] offset:0
    ds_write_b128 v21, v[36:39] offset:0
    v_mfma_f32_32x32x16_bf16 v[224:239], a[84:87], a[164:167], v[224:239]
    s_nop 0
    v_cvt_pk_bf16_f32 v40, v208, v209
    v_cvt_pk_bf16_f32 v41, v210, v211
    v_cvt_pk_bf16_f32 v42, v212, v213
    v_cvt_pk_bf16_f32 v43, v214, v215
    v_cvt_pk_bf16_f32 v44, v216, v217
    v_mfma_f32_32x32x16_bf16 v[224:239], a[88:91], a[168:171], v[224:239]
    v_cvt_pk_bf16_f32 v45, v218, v219
    v_cvt_pk_bf16_f32 v46, v220, v221
    v_cvt_pk_bf16_f32 v47, v222, v223
    v_permlane32_swap_b32 v40, v42
    v_permlane32_swap_b32 v41, v43
    v_mfma_f32_32x32x16_bf16 v[224:239], a[92:95], a[172:175], v[224:239]
    s_nop 0
    v_permlane32_swap_b32 v44, v46
    v_permlane32_swap_b32 v45, v47
    ds_write_b128 v22, v[40:43] offset:0
    ds_write_b128 v23, v[44:47] offset:0
    s_waitcnt lgkmcnt(0)
    v_mfma_f32_32x32x16_bf16 v[240:255], a[96:99], a[160:163], v[240:255]
    ds_read_b128 a[112:115], v17 offset:0
    ds_read_b128 a[116:119], v17 offset:1024
    ds_read_b128 a[120:123], v17 offset:2048
    ds_read_b128 a[124:127], v17 offset:3072
    v_mfma_f32_32x32x16_bf16 v[240:255], a[100:103], a[164:167], v[240:255]
    s_nop 0
    v_cvt_pk_bf16_f32 v32, v224, v225
    v_cvt_pk_bf16_f32 v33, v226, v227
    v_cvt_pk_bf16_f32 v34, v228, v229
    v_cvt_pk_bf16_f32 v35, v230, v231
    v_cvt_pk_bf16_f32 v36, v232, v233
    v_mfma_f32_32x32x16_bf16 v[240:255], a[104:107], a[168:171], v[240:255]
    s_waitcnt lgkmcnt(0)
    buffer_store_dwordx4 a[112:115], v18, s[16:19], s28 offen offset:0 sc1 nt
    buffer_store_dwordx4 a[116:119], v18, s[16:19], s29 offen offset:0 sc1 nt
    v_cvt_pk_bf16_f32 v37, v234, v235
    v_cvt_pk_bf16_f32 v38, v236, v237
    v_cvt_pk_bf16_f32 v39, v238, v239
    v_mfma_f32_32x32x16_bf16 v[240:255], a[108:111], a[172:175], v[240:255]
    buffer_store_dwordx4 a[120:123], v18, s[16:19], s30 offen offset:0 sc1 nt
    buffer_store_dwordx4 a[124:127], v18, s[16:19], s31 offen offset:0 sc1 nt
    s_cmp_eq_u32 s62, 13
    s_cbranch_scc1 standalone__weight_only_int_quip__prompt_kernel_yfin22
    v_permlane32_swap_b32 v32, v34
    v_permlane32_swap_b32 v33, v35
    s_nop 0
    v_permlane32_swap_b32 v36, v38
    v_permlane32_swap_b32 v37, v39
    ds_write_b128 v16, v[32:35] offset:4096
    ds_write_b128 v21, v[36:39] offset:4096
    s_nop 0
    v_cvt_pk_bf16_f32 v40, v240, v241
    v_cvt_pk_bf16_f32 v41, v242, v243
    v_cvt_pk_bf16_f32 v42, v244, v245
    v_cvt_pk_bf16_f32 v43, v246, v247
    v_cvt_pk_bf16_f32 v44, v248, v249
    v_cvt_pk_bf16_f32 v45, v250, v251
    v_cvt_pk_bf16_f32 v46, v252, v253
    v_cvt_pk_bf16_f32 v47, v254, v255
    v_permlane32_swap_b32 v40, v42
    v_permlane32_swap_b32 v41, v43
    s_nop 0
    v_permlane32_swap_b32 v44, v46
    v_permlane32_swap_b32 v45, v47
    ds_write_b128 v22, v[40:43] offset:4096
    ds_write_b128 v23, v[44:47] offset:4096
    s_waitcnt lgkmcnt(0)
    ds_read_b128 a[128:131], v17 offset:4096
    ds_read_b128 a[132:135], v17 offset:5120
    ds_read_b128 a[136:139], v17 offset:6144
    ds_read_b128 a[140:143], v17 offset:7168
    s_waitcnt lgkmcnt(3)
    buffer_store_dwordx4 a[128:131], v18, s[16:19], s28 offen offset:128 sc1 nt
    s_waitcnt lgkmcnt(2)
    buffer_store_dwordx4 a[132:135], v18, s[16:19], s29 offen offset:128 sc1 nt
    s_waitcnt lgkmcnt(1)
    buffer_store_dwordx4 a[136:139], v18, s[16:19], s30 offen offset:128 sc1 nt
    s_waitcnt lgkmcnt(0)
    buffer_store_dwordx4 a[140:143], v18, s[16:19], s31 offen offset:128 sc1 nt
standalone__weight_only_int_quip__prompt_kernel_yfin22:
    s_branch L_end
L_keeper:
    s_cmp_lg_u32 s5, 29
    s_cbranch_scc1 L_end
    s_cmp_lg_u32 s3, 0
    s_cbranch_scc1 L_end
    s_waitcnt lgkmcnt(0)

    s_add_u32 s32, s60, 7159808
    s_addc_u32 s33, s61, 0
    s_mov_b32 s34, 150784
    s_mov_b32 s35, 0x20000
    s_load_dword s39, s[32:33], 99328
    s_waitcnt lgkmcnt(0)
    s_mul_i32 s38, s39, 0x9E3779B1
    s_add_u32 s38, s38, 0x7F4A7C15
    s_xor_b32 s39, s38, 0x5BD1E995

    v_lshlrev_b32 v29, 3, v2
    v_add_u32 v29, 98304, v29
    s_mov_b32 s37, 0
standalone__weight_only_int_quip__prompt_kernel_pl24:
    buffer_load_dwordx2 v[8:9], v29, s[32:35], 0 offen sc1
    s_waitcnt vmcnt(0)
    v_cmp_ne_u64 vcc, s[38:39], v[8:9]
    s_cbranch_vccz standalone__weight_only_int_quip__prompt_kernel_wd23
    s_sleep 16

    s_add_u32 s37, s37, 1
    s_cmp_lt_u32 s37, 524288
    s_cbranch_scc1 standalone__weight_only_int_quip__prompt_kernel_pl24

standalone__weight_only_int_quip__prompt_kernel_wd23:
    v_min_u32 v29, 26, v2
    v_lshlrev_b32 v29, 3, v29
    v_add_u32 v29, 102400, v29
    s_mov_b32 s24, 7
L_kl:
    s_mov_b32 s37, 0
standalone__weight_only_int_quip__prompt_kernel_pl26:
    buffer_load_dwordx2 v[8:9], v29, s[32:35], 0 offen sc1
    s_waitcnt vmcnt(0)
    v_cmp_ne_u64 vcc, s[38:39], v[8:9]
    s_cbranch_vccz standalone__weight_only_int_quip__prompt_kernel_wd25
    s_sleep 1

    s_add_u32 s37, s37, 1
    s_cmp_lt_u32 s37, 524288
    s_cbranch_scc1 standalone__weight_only_int_quip__prompt_kernel_pl26

standalone__weight_only_int_quip__prompt_kernel_wd25:
    v_add_u32 v29, 6912, v29
    s_sub_u32 s24, s24, 1
    s_cmp_lg_u32 s24, 0
    s_cbranch_scc1 L_kl
    v_mov_b32 v30, s38
    v_mov_b32 v29, 99328
    s_mov_b64 exec, 1
    buffer_store_dword v30, v29, s[32:35], 0 offen sc1
    s_mov_b64 exec, -1

L_end:
standalone__weight_only_int_quip__prompt_kernel_done:
    s_endpgm
L_codeend:
.section .rodata,"a"
.p2align 6
.amdhsa_kernel standalone__weight_only_int_quip__prompt_kernel
  .amdhsa_next_free_vgpr 512
  .amdhsa_next_free_sgpr 100
  .amdhsa_accum_offset 256
  .amdhsa_group_segment_fixed_size 0
  .amdhsa_kernarg_size 72
  .amdhsa_user_sgpr_count 2
  .amdhsa_user_sgpr_kernarg_segment_ptr 1
  .amdhsa_system_sgpr_workgroup_id_x 1
.end_amdhsa_kernel
```
